```python
import torch

def _softmax(x, axis=-1):
    return torch.softmax(x, dim=axis)
def _gelu(x):
    return torch.nn.functional.gelu(x, approximate="tanh")
def _silu(x):
    return torch.nn.functional.silu(x)
def _sigmoid(x):
    return torch.sigmoid(x)
def _layernorm(x, axis=-1, eps=1e-5):
    m = x.mean(dim=axis, keepdim=True)
    v = x.var(dim=axis, keepdim=True, unbiased=False)
    return (x - m) / torch.sqrt(v + eps)
def _scatter_add(tgt, idx, src, axis=0):
    return tgt.clone().index_add_(axis, idx, src)
def _segment_sum(src, seg, n):
    out = torch.zeros((n,) + src.shape[1:], dtype=src.dtype)
    return out.index_add_(0, seg, src)
def _pad(x, pw):
    flat = tuple(v for pair in reversed(pw) for v in pair)
    return torch.nn.functional.pad(x, flat)

kernel_name = 'sequential_preLN__ssm_conv_s4__mixer_s_mlp__prompt'

def setup_inputs():

    _w = (lambda a: (lambda t: t.to(torch.bfloat16) if t.is_floating_point() else t)(torch.as_tensor(a)))
    def _A_setup():
        B, L, D, N = 1, 2048, 512, 128
        A_re = -(lambda _x: torch.exp(torch.as_tensor(_x)))((lambda *s: torch.randn(*s, dtype=torch.bfloat16) * 3.2)(D, N))
        A_im = torch.pi * (lambda *s: torch.randn(*s, dtype=torch.bfloat16) * 0.05)(D, N)
        B_re = (lambda *s: torch.randn(*s, dtype=torch.bfloat16) * 0.1)(D, N)
        B_im = (lambda *s: torch.randn(*s, dtype=torch.bfloat16) * 0.1)(D, N)
        C_re = (lambda *s: torch.randn(*s, dtype=torch.bfloat16) * 0.1)(D, N)
        C_im = (lambda *s: torch.randn(*s, dtype=torch.bfloat16) * 0.1)(D, N)
        log_dt = (lambda *s: torch.randn(*s, dtype=torch.bfloat16) * 0.05)(D) * 0.5 - 4.0
        Dskip = (lambda *s: torch.randn(*s, dtype=torch.bfloat16) * 0.05)(D)
        return {
            "u": _w((lambda *s: torch.randn(*s, dtype=torch.bfloat16) * 0.05)(B, L, D)),
            "A_re": _w(A_re),
            "A_im": _w(A_im),
            "B_re": _w(B_re),
            "B_im": _w(B_im),
            "C_re": _w(C_re),
            "C_im": _w(C_im),
            "log_dt": _w(log_dt),
            "Dskip": _w(Dskip),
        }
    _A_in = _A_setup()

    def _B_setup():
        B, S, D, F = 1, 2048, 512, 1792
        return {
            "x":  _w((lambda *s: torch.randn(*s, dtype=torch.bfloat16) * 0.05)(B, S, D)),
            "w1": _w((lambda *s: torch.randn(*s, dtype=torch.bfloat16) * 3.2)(D, D) * (D ** -0.5)),
            "w2": _w((lambda *s: torch.randn(*s, dtype=torch.bfloat16) * 3.2)(D, D) * (D ** -0.5)),
            "w3": _w((lambda *s: torch.randn(*s, dtype=torch.bfloat16) * 3.2)(D, F) * (D ** -0.5)),
            "w4": _w((lambda *s: torch.randn(*s, dtype=torch.bfloat16) * 1.6)(F, D) * (F ** -0.5)),
        }
    _B_in = _B_setup()

    return {
        "A_u": _A_in["u"],
        "A_A_re": _A_in["A_re"],
        "A_A_im": _A_in["A_im"],
        "A_B_re": _A_in["B_re"],
        "A_B_im": _A_in["B_im"],
        "A_C_re": _A_in["C_re"],
        "A_C_im": _A_in["C_im"],
        "A_log_dt": _A_in["log_dt"],
        "A_Dskip": _A_in["Dskip"],
        "B_x": _B_in["x"],
        "B_w1": _B_in["w1"],
        "B_w2": _B_in["w2"],
        "B_w3": _B_in["w3"],
        "B_w4": _B_in["w4"],
    }

def reference(A_u, A_A_re, A_A_im, A_B_re, A_B_im, A_C_re, A_C_im, A_log_dt, A_Dskip, B_x, B_w1, B_w2, B_w3, B_w4):
    def _A_ref(u, A_re, A_im, B_re, B_im, C_re, C_im, log_dt, Dskip):
        Bsz, L, D = u.shape
        dt = torch.exp(log_dt)[:, None]
        A = A_re + 1j * A_im
        Bc = B_re + 1j * B_im
        Cc = C_re + 1j * C_im
        logdA = dt * A
        dB = dt * Bc
        l = (lambda x, dt: x.to(dt))(torch.arange(L), A_re.dtype)
        P = torch.exp(logdA[:, :, None] * l[None, None, :])
        K = torch.einsum("dn,dnl,dn->dl", Cc, P, dB).real
        L2 = 2 * L
        Kp = _pad(K, ((0, 0), (0, L)))
        up = (lambda x, *d: x.permute(*d))(u, 0, 2, 1)
        up = _pad(up, ((0, 0), (0, 0), (0, L)))
        Kf = (lambda x, axes=(-2,-1): torch.fft.rfft2(x.float(), dim=axes))(Kp[:, None, :], axes=(-2, -1))
        Uf = (lambda x, axes=(-2,-1): torch.fft.rfft2(x.float(), dim=axes))(up[:, :, None, :], axes=(-2, -1))
        Yf = Uf * Kf[None, :, :, :]
        y = (lambda x, s, axes=(-2,-1): torch.fft.irfft2(x, s=s, dim=axes).to(torch.bfloat16))(Yf, (1, L2), axes=(-2, -1))[:, :, 0, :L]
        y = (lambda x, *d: x.permute(*d))(y, 0, 2, 1) + u * Dskip[None, None, :]
        return y

    def _B_ref(x, w1, w2, w3, w4):
        B, S, D = x.shape
        h = _gelu(_layernorm(x, axis=-1) @ w1)
        c = D // 4
        g0 = _pad(h[:, :, 0*c:1*c], ((0, 0), (1, 0), (0, 0)))[:, :S, :]
        g1 = _pad(h[:, :, 1*c:2*c], ((0, 0), (0, 1), (0, 0)))[:, 1:, :]
        g2 = _pad(h[:, :, 2*c:3*c], ((0, 0), (2, 0), (0, 0)))[:, :S, :]
        g3 = _pad(h[:, :, 3*c:   ], ((0, 0), (0, 2), (0, 0)))[:, 2:, :]
        hs = torch.concatenate([g0, g1, g2, g3], axis=-1) @ w2
        x1 = x + hs
        h2 = _gelu(_layernorm(x1, axis=-1) @ w3) @ w4
        return x1 + h2

    x = A_u
    h = x + _A_ref(_layernorm(x, axis=-1), A_A_re, A_A_im, A_B_re, A_B_im, A_C_re, A_C_im, A_log_dt, A_Dskip)
    h2 = h + _B_ref(_layernorm(h, axis=-1), B_w1, B_w2, B_w3, B_w4)
    return h2
```

```asm
; @launch kernel=k2_kernel grid=(256,1,1) block=(512,1,1) lds=136832
; @launch kernel=k3_kernel grid=(256,1,1) block=(768,1,1) lds=152576
; @launch kernel=k4_kernel grid=(256,1,1) block=(768,1,1) lds=155648
; @launch kernel=k5_kernel grid=(224,1,1) block=(768,1,1) lds=151552
; @launch kernel=k6_kernel grid=(256,1,1) block=(768,1,1) lds=163840
.amdgcn_target "amdgcn-amd-amdhsa--gfx950"
.text
.globl k2_kernel
.p2align 8
.type k2_kernel,@function
k2_kernel:
    s_cmp_ge_u32 s2, 256
    s_cbranch_scc1 K2_END
    s_load_dwordx16 s[16:31], s[0:1], 0
    s_load_dwordx2 s[34:35], s[0:1], 64
    s_load_dwordx4 s[48:51], s[0:1], 120
    s_load_dwordx8 s[52:59], s[0:1], 80
    s_getpc_b64 s[46:47]
K2_SELF:
    v_lshlrev_b32 v1, 4, v0
    global_load_dwordx4 v[196:199], v1, s[46:47]
    v_add_u32 v1, 0x2000, v1
    v_cmp_gt_u32 vcc, K2_END-K2_SELF-16, v1
    s_and_saveexec_b64 s[42:43], vcc
    global_load_dwordx4 v[204:207], v1, s[46:47]
    s_mov_b64 exec, -1
    v_lshrrev_b32 v1, 6, v0
    s_nop 0
    v_readfirstlane_b32 s8, v1
    v_and_b32 v2, 63, v0
    s_lshl_b32 s5, s2, 13
    v_lshlrev_b32 v6, 4, v0
    v_add_u32 v6, s5, v6
    s_lshr_b32 s9, s8, 2
    s_and_b32 s10, s8, 3
    s_and_b32 s3, s2, 7
    s_lshl_b32 s3, s3, 5
    s_lshr_b32 s4, s2, 3
    s_add_u32 s61, s3, s4
    s_lshl_b32 s3, s61, 2
    v_lshlrev_b32 v13, 12, v0
    v_add_u32 v13, s3, v13
    v_and_b32 v3, 31, v2
    s_lshl_b32 s4, s8, 5
    v_add_u32 v3, s4, v3
    s_lshl_b32 s4, s61, 8
    v_add_u32 v4, s4, v3
    v_lshlrev_b32 v4, 1, v4
    s_lshl_b32 s4, s61, 1
    s_add_u32 s4, s4, s9
    s_lshl_b32 s5, s4, 1
    v_mov_b32 v5, s5
    s_waitcnt lgkmcnt(0)
    s_mov_b32 s32, s50
    s_mov_b32 s33, s51
    s_load_dword s15, s[34:35], s3
    global_load_dwordx4 v[64:67], v6, s[16:17]
    global_load_ushort v20, v4, s[18:19]
    global_load_ushort v21, v4, s[20:21]
    global_load_ushort v22, v4, s[22:23]
    global_load_ushort v23, v4, s[24:25]
    global_load_ushort v24, v4, s[26:27]
    global_load_ushort v25, v4, s[28:29]
    global_load_ushort v26, v5, s[30:31]
    s_add_u32 s36, s32, 29884416
    s_addc_u32 s37, s33, 0
    s_add_u32 s44, s32, 8388608
    s_addc_u32 s45, s33, 0
    v_and_b32 v9, 15, v2
    v_lshrrev_b32 v10, 4, v2
    v_and_b32 v5, 255, v0
    s_mul_i32 s5, s9, 34304
    s_add_u32 s5, s5, 68224
    v_lshlrev_b32 v7, 4, v5
    v_add_u32 v7, s5, v7
    s_mul_i32 s3, s4, 4224
    s_lshl_b32 s6, s10, 10
    s_add_u32 s3, s3, s6
    v_lshlrev_b32 v11, 5, v9
    v_lshl_add_u32 v11, v10, 3, v11
    v_add_u32 v12, s3, v11
    v_add_u32 v15, s5, v11
    v_add_u32 v15, s6, v15
    s_mov_b32 s23, 0xffff0000
    s_mov_b32 s11, 0x3b000000
    s_mov_b32 s14, 0x3727c5ac
    v_lshlrev_b32 v40, 1, v9
    v_cvt_f32_u32 v42, v40
    v_lshlrev_b32 v40, 5, v9
    v_cvt_f32_u32 v46, v40
    v_lshlrev_b32 v40, 2, v9
    v_add_u32 v40, 0x200, v40
    v_and_b32 v45, 3, v9
    v_lshlrev_b32 v45, 3, v45
    v_bfe_u32 v41, v9, 2, 1
    v_lshlrev_b32 v41, 9, v41
    v_add3_u32 v45, v45, v41, 0
    v_add_u32 v45, 0x400, v45
    v_cmp_gt_u32 vcc, 8, v9
    s_nop 1
    v_cndmask_b32 v40, v45, v40, vcc
    v_cvt_f32_u32 v44, v40
    v_lshlrev_b32 v39, 3, v3
    v_lshlrev_b32 v3, 4, v3
    s_lshl_b32 s5, s8, 9
    v_lshlrev_b32 v8, 6, v10
    v_add_u32 v8, s5, v8
    v_lshrrev_b32 v38, 1, v8
    s_mul_i32 s5, s8, 3072
    s_add_u32 s5, s5, 6208
    v_lshlrev_b32 v47, 4, v2
    v_add_u32 v47, s5, v47
    v_mov_b32 v48, 0
    v_mov_b32 v49, 0
    v_mov_b32 v50, 0
    v_mov_b32 v51, 0
    v_mov_b32 v52, 0
    v_mov_b32 v53, 0
    v_mov_b32 v54, 0
    v_mov_b32 v55, 0
    v_mov_b32 v56, 0
    v_mov_b32 v57, 0
    v_mov_b32 v58, 0
    v_mov_b32 v59, 0
    v_mul_u32_u24 v60, 205, v0
    v_lshrrev_b32 v60, 13, v60
    v_mul_u32_u24 v61, 40, v60
    v_sub_u32 v61, v0, v61
    v_lshlrev_b32 v62, 4, v61
    v_add_u32 v63, 0x1000, v62
    v_cmp_gt_u32 vcc, 4, v61
    s_nop 1
    v_cndmask_b32 v62, v63, v62, vcc
    v_mul_u32_u24 v60, 5120, v60
    v_add3_u32 v62, v62, v60, 0
    v_add_u32 v62, 47744, v62
    v_cmp_gt_u32 vcc, 160, v0
    s_and_saveexec_b64 s[42:43], vcc
    ds_write_b128 v62, v[48:51]
    s_mov_b64 exec, s[42:43]
    s_waitcnt vmcnt(7)
    v_lshlrev_b32 v72, 16, v64
    v_and_b32 v73, s23, v64
    v_lshlrev_b32 v74, 16, v65
    v_and_b32 v75, s23, v65
    v_lshlrev_b32 v76, 16, v66
    v_and_b32 v77, s23, v66
    v_lshlrev_b32 v78, 16, v67
    v_and_b32 v79, s23, v67
    v_readfirstlane_b32 s5, v72
    v_mov_b32 v80, 0
    v_mov_b32 v81, 0
    v_subrev_f32 v82, s5, v72
    v_add_f32 v80, v80, v82
    v_fmac_f32 v81, v82, v82
    v_subrev_f32 v82, s5, v73
    v_add_f32 v80, v80, v82
    v_fmac_f32 v81, v82, v82
    v_subrev_f32 v82, s5, v74
    v_add_f32 v80, v80, v82
    v_fmac_f32 v81, v82, v82
    v_subrev_f32 v82, s5, v75
    v_add_f32 v80, v80, v82
    v_fmac_f32 v81, v82, v82
    v_subrev_f32 v82, s5, v76
    v_add_f32 v80, v80, v82
    v_fmac_f32 v81, v82, v82
    v_subrev_f32 v82, s5, v77
    v_add_f32 v80, v80, v82
    v_fmac_f32 v81, v82, v82
    v_subrev_f32 v82, s5, v78
    v_add_f32 v80, v80, v82
    v_fmac_f32 v81, v82, v82
    v_subrev_f32 v82, s5, v79
    v_add_f32 v80, v80, v82
    v_fmac_f32 v81, v82, v82
    s_nop 0
    v_add_f32_dpp v80, v80, v80 row_shr:1 row_mask:0xf bank_mask:0xf
    v_add_f32_dpp v81, v81, v81 row_shr:1 row_mask:0xf bank_mask:0xf
    s_nop 0
    v_add_f32_dpp v80, v80, v80 row_shr:2 row_mask:0xf bank_mask:0xf
    v_add_f32_dpp v81, v81, v81 row_shr:2 row_mask:0xf bank_mask:0xf
    s_nop 0
    v_add_f32_dpp v80, v80, v80 row_shr:4 row_mask:0xf bank_mask:0xf
    v_add_f32_dpp v81, v81, v81 row_shr:4 row_mask:0xf bank_mask:0xf
    s_nop 0
    v_add_f32_dpp v80, v80, v80 row_shr:8 row_mask:0xf bank_mask:0xf
    v_add_f32_dpp v81, v81, v81 row_shr:8 row_mask:0xf bank_mask:0xf
    s_nop 0
    v_add_f32_dpp v80, v80, v80 row_bcast:15 row_mask:0xa bank_mask:0xf
    v_add_f32_dpp v81, v81, v81 row_bcast:15 row_mask:0xa bank_mask:0xf
    s_nop 0
    v_add_f32_dpp v80, v80, v80 row_bcast:31 row_mask:0xc bank_mask:0xf
    v_add_f32_dpp v81, v81, v81 row_bcast:31 row_mask:0xc bank_mask:0xf
    v_mul_f32 v80, s11, v80
    v_mul_f32 v81, s11, v81
    v_fma_f32 v81, -v80, v80, v81
    v_max_f32 v81, 0, v81
    v_add_f32 v80, s5, v80
    v_cvt_pk_bf16_f32 v81, v81, v81
    v_lshlrev_b32 v81, 16, v81
    v_add_f32 v81, s14, v81
    v_cvt_pk_bf16_f32 v81, v81, v81
    v_lshlrev_b32 v81, 16, v81
    v_sqrt_f32 v81, v81
    s_nop 0
    v_cvt_pk_bf16_f32 v81, v81, v81
    v_lshlrev_b32 v81, 16, v81
    v_cvt_pk_bf16_f32 v80, v80, v80
    v_lshlrev_b32 v80, 16, v80
    s_lshl_b32 s5, s8, 3
    v_mov_b32 v82, s5
    s_mov_b32 exec_lo, 0
    s_mov_b32 exec_hi, 0x80000000
    ds_write_b64 v82, v[80:81] offset:6144
    s_mov_b64 exec, -1
    s_waitcnt vmcnt(0) lgkmcnt(0)
    s_barrier
    s_cmp_eq_u32 s8, 0
    s_cbranch_scc1 K2_W0
    global_load_dword v144, v13, s[16:17] offset:0
    global_load_dword v145, v13, s[16:17] offset:1024
    global_load_dword v146, v13, s[16:17] offset:2048
    global_load_dword v147, v13, s[16:17] offset:3072
    s_getpc_b64 s[46:47]
K2_PCBASEA:
    s_lshr_b32 s5, s2, 3
    s_lshl_b32 s5, s5, 13
    v_lshlrev_b32 v86, 4, v0
    v_add_u32 v86, s5, v86
    v_cmp_gt_u32 vcc, K6_END-K2_PCBASEA-16, v86
    s_and_saveexec_b64 s[42:43], vcc
    s_cbranch_execz K2_NOCODEA
    global_load_dwordx4 v[200:203], v86, s[46:47]
K2_NOCODEA:
    s_mov_b64 exec, -1
    s_cmp_ge_u32 s2, 144
    s_cbranch_scc1 K2_PFJA
    s_mul_hi_u32 s12, s2, 238609295
    s_mul_i32 s5, s12, 18
    s_sub_u32 s13, s2, s5
    v_lshrrev_b32 v86, 4, v0
    v_and_b32 v85, 15, v0
    s_cmp_lt_u32 s13, 4
    s_mov_b32 s5, 1024
    s_cselect_b32 s5, s5, 3584
    s_cselect_b32 s6, 0, 4
    s_cselect_b32 s46, s52, s56
    s_cselect_b32 s47, s53, s57
    s_sub_u32 s6, s13, s6
    s_lshl_b32 s7, s12, 6
    v_add_u32 v86, s7, v86
    v_mul_lo_u32 v86, v86, s5
    v_lshl_add_u32 v86, v85, 4, v86
    s_lshl_b32 s7, s6, 8
    v_add_u32 v86, s7, v86
    s_lshl_b32 s5, s5, 5
    v_add_u32 v85, s5, v86
    global_load_dwordx4 v[176:179], v86, s[46:47]
    global_load_dwordx4 v[180:183], v85, s[46:47]
    s_branch K2_SIDE_DONEA
K2_PFJA:
    s_sub_u32 s5, s2, 144
    s_mov_b32 s40, s54
    s_mov_b32 s41, s55
    s_mov_b32 s42, 524288
    s_mov_b32 s43, 0x00020000
    s_lshl_b32 s6, s5, 13
    v_lshlrev_b32 v86, 4, v0
    v_add_u32 v86, s6, v86
    buffer_load_dwordx4 v[184:187], v86, s[40:43], 0 offen
    s_mov_b32 s40, s58
    s_mov_b32 s41, s59
    s_mov_b32 s42, 1835008
    v_add_u32 v86, s6, v86
    v_add_u32 v85, 0x2000, v86
    buffer_load_dwordx4 v[188:191], v86, s[40:43], 0 offen
    buffer_load_dwordx4 v[192:195], v85, s[40:43], 0 offen
K2_SIDE_DONEA:
    s_branch K2_W0D
K2_W0:
    v_lshlrev_b32 v82, 3, v2
    s_lshl_b32 s3, s2, 6
    v_add_u32 v83, s3, v82
    s_mov_b64 exec, 0xff
    ds_read_b64 v[80:81], v82 offset:6144
    s_waitcnt lgkmcnt(0)
    global_store_dwordx2 v83, v[80:81], s[36:37] sc1
    s_mov_b64 exec, -1
K2_W0D:
    s_mov_b32 s4, 0x3fb8aa3b
    s_mov_b32 s5, 0x32a57060
    s_mov_b32 s6, 0x3f317218
    s_mov_b32 s7, 0x45000000
    v_lshlrev_b32 v20, 16, v20
    v_lshlrev_b32 v21, 16, v21
    v_lshlrev_b32 v22, 16, v22
    v_lshlrev_b32 v23, 16, v23
    v_lshlrev_b32 v24, 16, v24
    v_lshlrev_b32 v25, 16, v25
    v_lshlrev_b32 v26, 16, v26
    v_mul_f32 v27, s4, v26
    v_fma_f32 v28, v26, s4, -v27
    v_fmac_f32 v28, s5, v26
    v_exp_f32 v27, v27
    v_mul_f32 v28, s6, v28
    v_fma_f32 v27, v27, v28, v27
    v_cvt_pk_bf16_f32 v27, v27, v27
    v_lshlrev_b32 v27, 16, v27
    v_mul_f32 v20, v27, v20
    v_mul_f32 v21, v27, v21
    v_mul_f32 v22, v27, v22
    v_mul_f32 v23, v27, v23
    v_mul_f32 v32, s4, v20
    v_mul_f32 v33, 0.15915494, v21
    v_mul_f32 v34, v24, v22
    v_mul_f32 v35, v24, v23
    v_fma_f32 v34, -v25, v23, v34
    v_fma_f32 v35, v25, v22, v35
    ds_write_b128 v3, v[32:35] offset:0
    v_fract_f32 v29, v33
    v_exp_f32 v28, v32
    v_sin_f32 v31, v29
    v_cos_f32 v30, v29
    v_mul_f32 v36, s7, v32
    v_mul_f32 v37, s7, v33
    v_mul_f32 v30, v28, v30
    v_mul_f32 v31, v28, v31
    ds_write_b64 v39, v[30:31] offset:4096
    v_fract_f32 v37, v37
    v_exp_f32 v36, v36
    v_sin_f32 v28, v37
    v_cos_f32 v29, v37
    s_nop 0
    v_mul_f32 v29, v34, v29
    v_fma_f32 v29, -v35, v28, v29
    v_mul_f32 v29, v36, v29
    s_nop 1
    v_add_f32_dpp v29, v29, v29 row_shr:1 row_mask:0xf bank_mask:0xf
    s_nop 1
    v_add_f32_dpp v29, v29, v29 row_shr:2 row_mask:0xf bank_mask:0xf
    s_nop 1
    v_add_f32_dpp v29, v29, v29 row_shr:4 row_mask:0xf bank_mask:0xf
    s_nop 1
    v_add_f32_dpp v29, v29, v29 row_shr:8 row_mask:0xf bank_mask:0xf
    s_nop 1
    v_add_f32_dpp v29, v29, v29 row_bcast:15 row_mask:0xa bank_mask:0xf
    s_lshl_b32 s11, s8, 2
    v_mov_b32 v36, s11
    s_mov_b32 exec_lo, 0x80000000
    s_mov_b32 exec_hi, 0
    ds_write_b32 v36, v29 offset:30784
    s_mov_b64 exec, -1
    s_waitcnt lgkmcnt(0)
    s_cmp_lg_u32 s8, 0
    s_cbranch_scc1 K2_NOSIG
    s_waitcnt vmcnt(0)
    s_and_b32 s3, s2, 3
    s_lshl_b32 s3, s3, 6
    v_mov_b32 v36, s3
    v_mov_b32 v37, 1
    s_mov_b64 exec, 1
    global_atomic_add v36, v37, s[48:49] sc1
    s_mov_b64 exec, -1
    global_load_dword v144, v13, s[16:17] offset:0
    global_load_dword v145, v13, s[16:17] offset:1024
    global_load_dword v146, v13, s[16:17] offset:2048
    global_load_dword v147, v13, s[16:17] offset:3072
    s_getpc_b64 s[46:47]
K2_PCBASEB:
    s_lshr_b32 s5, s2, 3
    s_lshl_b32 s5, s5, 13
    v_lshlrev_b32 v86, 4, v0
    v_add_u32 v86, s5, v86
    v_cmp_gt_u32 vcc, K6_END-K2_PCBASEB-16, v86
    s_and_saveexec_b64 s[42:43], vcc
    s_cbranch_execz K2_NOCODEB
    global_load_dwordx4 v[200:203], v86, s[46:47]
K2_NOCODEB:
    s_mov_b64 exec, -1
    s_cmp_ge_u32 s2, 144
    s_cbranch_scc1 K2_PFJB
    s_mul_hi_u32 s12, s2, 238609295
    s_mul_i32 s5, s12, 18
    s_sub_u32 s13, s2, s5
    v_lshrrev_b32 v86, 4, v0
    v_and_b32 v85, 15, v0
    s_cmp_lt_u32 s13, 4
    s_mov_b32 s5, 1024
    s_cselect_b32 s5, s5, 3584
    s_cselect_b32 s6, 0, 4
    s_cselect_b32 s46, s52, s56
    s_cselect_b32 s47, s53, s57
    s_sub_u32 s6, s13, s6
    s_lshl_b32 s7, s12, 6
    v_add_u32 v86, s7, v86
    v_mul_lo_u32 v86, v86, s5
    v_lshl_add_u32 v86, v85, 4, v86
    s_lshl_b32 s7, s6, 8
    v_add_u32 v86, s7, v86
    s_lshl_b32 s5, s5, 5
    v_add_u32 v85, s5, v86
    global_load_dwordx4 v[176:179], v86, s[46:47]
    global_load_dwordx4 v[180:183], v85, s[46:47]
    s_branch K2_SIDE_DONEB
K2_PFJB:
    s_sub_u32 s5, s2, 144
    s_mov_b32 s40, s54
    s_mov_b32 s41, s55
    s_mov_b32 s42, 524288
    s_mov_b32 s43, 0x00020000
    s_lshl_b32 s6, s5, 13
    v_lshlrev_b32 v86, 4, v0
    v_add_u32 v86, s6, v86
    buffer_load_dwordx4 v[184:187], v86, s[40:43], 0 offen
    s_mov_b32 s40, s58
    s_mov_b32 s41, s59
    s_mov_b32 s42, 1835008
    v_add_u32 v86, s6, v86
    v_add_u32 v85, 0x2000, v86
    buffer_load_dwordx4 v[188:191], v86, s[40:43], 0 offen
    buffer_load_dwordx4 v[192:195], v85, s[40:43], 0 offen
K2_SIDE_DONEB:
K2_NOSIG:
    ds_read_b128 v[80:83], v8 offset:0
    ds_read_b128 v[84:87], v8 offset:16
    ds_read_b128 v[88:91], v8 offset:32
    ds_read_b128 v[92:95], v8 offset:48
    ds_read_b128 v[116:119], v38 offset:4096
    ds_read_b128 v[120:123], v38 offset:4112
    s_waitcnt lgkmcnt(0)
    v_pk_mul_f32 v[124:125], v[80:81], v[46:47] op_sel_hi:[1,0]
    v_pk_mul_f32 v[126:127], v[84:85], v[46:47] op_sel_hi:[1,0]
    v_pk_mul_f32 v[128:129], v[88:89], v[46:47] op_sel_hi:[1,0]
    v_pk_mul_f32 v[130:131], v[92:93], v[46:47] op_sel_hi:[1,0]
    v_fract_f32 v125, v125
    v_fract_f32 v127, v127
    v_fract_f32 v129, v129
    v_fract_f32 v131, v131
    v_exp_f32 v124, v124
    v_exp_f32 v126, v126
    v_exp_f32 v128, v128
    v_exp_f32 v130, v130
    v_sin_f32 v133, v125
    v_sin_f32 v135, v127
    v_sin_f32 v137, v129
    v_sin_f32 v139, v131
    v_cos_f32 v132, v125
    v_cos_f32 v134, v127
    v_cos_f32 v136, v129
    v_cos_f32 v138, v131
    v_pk_mul_f32 v[132:133], v[132:133], v[124:125] op_sel_hi:[1,0]
    v_pk_mul_f32 v[134:135], v[134:135], v[126:127] op_sel_hi:[1,0]
    v_pk_mul_f32 v[136:137], v[136:137], v[128:129] op_sel_hi:[1,0]
    v_pk_mul_f32 v[138:139], v[138:139], v[130:131] op_sel_hi:[1,0]
    v_pk_mul_f32 v[160:161], v[132:133], v[82:83] op_sel_hi:[1,0] neg_hi:[0,1]
    v_pk_mul_f32 v[162:163], v[134:135], v[86:87] op_sel_hi:[1,0] neg_hi:[0,1]
    v_pk_mul_f32 v[164:165], v[136:137], v[90:91] op_sel_hi:[1,0] neg_hi:[0,1]
    v_pk_mul_f32 v[166:167], v[138:139], v[94:95] op_sel_hi:[1,0] neg_hi:[0,1]
    v_pk_fma_f32 v[160:161], v[132:133], v[82:83], v[160:161] op_sel:[1,1,0] op_sel_hi:[0,1,1] neg_lo:[0,1,0] neg_hi:[0,1,0]
    v_pk_fma_f32 v[162:163], v[134:135], v[86:87], v[162:163] op_sel:[1,1,0] op_sel_hi:[0,1,1] neg_lo:[0,1,0] neg_hi:[0,1,0]
    v_pk_fma_f32 v[164:165], v[136:137], v[90:91], v[164:165] op_sel:[1,1,0] op_sel_hi:[0,1,1] neg_lo:[0,1,0] neg_hi:[0,1,0]
    v_pk_fma_f32 v[166:167], v[138:139], v[94:95], v[166:167] op_sel:[1,1,0] op_sel_hi:[0,1,1] neg_lo:[0,1,0] neg_hi:[0,1,0]
    v_cvt_pk_bf16_f32 v96, v160, v161
    v_cvt_pk_bf16_f32 v97, v162, v163
    v_cvt_pk_bf16_f32 v98, v164, v165
    v_cvt_pk_bf16_f32 v99, v166, v167
    v_lshlrev_b32 v124, 16, v96
    v_and_b32 v125, s23, v96
    v_lshlrev_b32 v126, 16, v97
    v_and_b32 v127, s23, v97
    v_lshlrev_b32 v128, 16, v98
    v_and_b32 v129, s23, v98
    v_lshlrev_b32 v130, 16, v99
    v_and_b32 v131, s23, v99
    v_pk_add_f32 v[124:125], v[160:161], v[124:125] neg_lo:[0,1] neg_hi:[0,1]
    v_pk_add_f32 v[126:127], v[162:163], v[126:127] neg_lo:[0,1] neg_hi:[0,1]
    v_pk_add_f32 v[128:129], v[164:165], v[128:129] neg_lo:[0,1] neg_hi:[0,1]
    v_pk_add_f32 v[130:131], v[166:167], v[130:131] neg_lo:[0,1] neg_hi:[0,1]
    v_cvt_pk_bf16_f32 v100, v124, v125
    v_cvt_pk_bf16_f32 v101, v126, v127
    v_cvt_pk_bf16_f32 v102, v128, v129
    v_cvt_pk_bf16_f32 v103, v130, v131
    v_pk_mul_f32 v[124:125], v[80:81], v[42:43] op_sel_hi:[1,0]
    v_pk_mul_f32 v[126:127], v[84:85], v[42:43] op_sel_hi:[1,0]
    v_pk_mul_f32 v[128:129], v[88:89], v[42:43] op_sel_hi:[1,0]
    v_pk_mul_f32 v[130:131], v[92:93], v[42:43] op_sel_hi:[1,0]
    v_fract_f32 v125, v125
    v_fract_f32 v127, v127
    v_fract_f32 v129, v129
    v_fract_f32 v131, v131
    v_exp_f32 v124, v124
    v_exp_f32 v126, v126
    v_exp_f32 v128, v128
    v_exp_f32 v130, v130
    v_sin_f32 v133, v125
    v_sin_f32 v135, v127
    v_sin_f32 v137, v129
    v_sin_f32 v139, v131
    v_cos_f32 v132, v125
    v_cos_f32 v134, v127
    v_cos_f32 v136, v129
    v_cos_f32 v138, v131
    v_pk_mul_f32 v[132:133], v[132:133], v[124:125] op_sel_hi:[1,0]
    v_pk_mul_f32 v[134:135], v[134:135], v[126:127] op_sel_hi:[1,0]
    v_pk_mul_f32 v[136:137], v[136:137], v[128:129] op_sel_hi:[1,0]
    v_pk_mul_f32 v[138:139], v[138:139], v[130:131] op_sel_hi:[1,0]
    v_cvt_pk_bf16_f32 v104, v132, v133
    v_cvt_pk_bf16_f32 v105, v134, v135
    v_cvt_pk_bf16_f32 v106, v136, v137
    v_cvt_pk_bf16_f32 v107, v138, v139
    v_lshlrev_b32 v124, 16, v104
    v_and_b32 v125, s23, v104
    v_lshlrev_b32 v126, 16, v105
    v_and_b32 v127, s23, v105
    v_lshlrev_b32 v128, 16, v106
    v_and_b32 v129, s23, v106
    v_lshlrev_b32 v130, 16, v107
    v_and_b32 v131, s23, v107
    v_pk_add_f32 v[124:125], v[132:133], v[124:125] neg_lo:[0,1] neg_hi:[0,1]
    v_pk_add_f32 v[126:127], v[134:135], v[126:127] neg_lo:[0,1] neg_hi:[0,1]
    v_pk_add_f32 v[128:129], v[136:137], v[128:129] neg_lo:[0,1] neg_hi:[0,1]
    v_pk_add_f32 v[130:131], v[138:139], v[130:131] neg_lo:[0,1] neg_hi:[0,1]
    v_cvt_pk_bf16_f32 v108, v124, v125
    v_cvt_pk_bf16_f32 v109, v126, v127
    v_cvt_pk_bf16_f32 v110, v128, v129
    v_cvt_pk_bf16_f32 v111, v130, v131
    v_mfma_f32_16x16x32_bf16 v[48:51], v[104:107], v[96:99], v[48:51]
    v_mfma_f32_16x16x32_bf16 v[48:51], v[104:107], v[100:103], v[48:51]
    v_mfma_f32_16x16x32_bf16 v[48:51], v[108:111], v[96:99], v[48:51]
    v_pk_mul_f32 v[160:161], v[132:133], v[116:117] op_sel_hi:[1,0]
    v_pk_mul_f32 v[162:163], v[134:135], v[118:119] op_sel_hi:[1,0]
    v_pk_mul_f32 v[164:165], v[136:137], v[120:121] op_sel_hi:[1,0]
    v_pk_mul_f32 v[166:167], v[138:139], v[122:123] op_sel_hi:[1,0]
    v_pk_fma_f32 v[160:161], v[132:133], v[116:117], v[160:161] op_sel:[1,1,0] op_sel_hi:[0,1,1] neg_lo:[0,1,0]
    v_pk_fma_f32 v[162:163], v[134:135], v[118:119], v[162:163] op_sel:[1,1,0] op_sel_hi:[0,1,1] neg_lo:[0,1,0]
    v_pk_fma_f32 v[164:165], v[136:137], v[120:121], v[164:165] op_sel:[1,1,0] op_sel_hi:[0,1,1] neg_lo:[0,1,0]
    v_pk_fma_f32 v[166:167], v[138:139], v[122:123], v[166:167] op_sel:[1,1,0] op_sel_hi:[0,1,1] neg_lo:[0,1,0]
    v_cvt_pk_bf16_f32 v104, v160, v161
    v_cvt_pk_bf16_f32 v105, v162, v163
    v_cvt_pk_bf16_f32 v106, v164, v165
    v_cvt_pk_bf16_f32 v107, v166, v167
    v_lshlrev_b32 v124, 16, v104
    v_and_b32 v125, s23, v104
    v_lshlrev_b32 v126, 16, v105
    v_and_b32 v127, s23, v105
    v_lshlrev_b32 v128, 16, v106
    v_and_b32 v129, s23, v106
    v_lshlrev_b32 v130, 16, v107
    v_and_b32 v131, s23, v107
    v_pk_add_f32 v[124:125], v[160:161], v[124:125] neg_lo:[0,1] neg_hi:[0,1]
    v_pk_add_f32 v[126:127], v[162:163], v[126:127] neg_lo:[0,1] neg_hi:[0,1]
    v_pk_add_f32 v[128:129], v[164:165], v[128:129] neg_lo:[0,1] neg_hi:[0,1]
    v_pk_add_f32 v[130:131], v[166:167], v[130:131] neg_lo:[0,1] neg_hi:[0,1]
    v_cvt_pk_bf16_f32 v108, v124, v125
    v_cvt_pk_bf16_f32 v109, v126, v127
    v_cvt_pk_bf16_f32 v110, v128, v129
    v_cvt_pk_bf16_f32 v111, v130, v131
    v_mfma_f32_16x16x32_bf16 v[52:55], v[104:107], v[96:99], v[52:55]
    v_mfma_f32_16x16x32_bf16 v[52:55], v[104:107], v[100:103], v[52:55]
    v_mfma_f32_16x16x32_bf16 v[52:55], v[108:111], v[96:99], v[52:55]
    v_pk_mul_f32 v[124:125], v[80:81], v[44:45] op_sel_hi:[1,0]
    v_pk_mul_f32 v[126:127], v[84:85], v[44:45] op_sel_hi:[1,0]
    v_pk_mul_f32 v[128:129], v[88:89], v[44:45] op_sel_hi:[1,0]
    v_pk_mul_f32 v[130:131], v[92:93], v[44:45] op_sel_hi:[1,0]
    v_fract_f32 v125, v125
    v_fract_f32 v127, v127
    v_fract_f32 v129, v129
    v_fract_f32 v131, v131
    v_exp_f32 v124, v124
    v_exp_f32 v126, v126
    v_exp_f32 v128, v128
    v_exp_f32 v130, v130
    v_sin_f32 v133, v125
    v_sin_f32 v135, v127
    v_sin_f32 v137, v129
    v_sin_f32 v139, v131
    v_cos_f32 v132, v125
    v_cos_f32 v134, v127
    v_cos_f32 v136, v129
    v_cos_f32 v138, v131
    v_pk_mul_f32 v[132:133], v[132:133], v[124:125] op_sel_hi:[1,0]
    v_pk_mul_f32 v[134:135], v[134:135], v[126:127] op_sel_hi:[1,0]
    v_pk_mul_f32 v[136:137], v[136:137], v[128:129] op_sel_hi:[1,0]
    v_pk_mul_f32 v[138:139], v[138:139], v[130:131] op_sel_hi:[1,0]
    v_cvt_pk_bf16_f32 v104, v132, v133
    v_cvt_pk_bf16_f32 v105, v134, v135
    v_cvt_pk_bf16_f32 v106, v136, v137
    v_cvt_pk_bf16_f32 v107, v138, v139
    v_lshlrev_b32 v124, 16, v104
    v_and_b32 v125, s23, v104
    v_lshlrev_b32 v126, 16, v105
    v_and_b32 v127, s23, v105
    v_lshlrev_b32 v128, 16, v106
    v_and_b32 v129, s23, v106
    v_lshlrev_b32 v130, 16, v107
    v_and_b32 v131, s23, v107
    v_pk_add_f32 v[124:125], v[132:133], v[124:125] neg_lo:[0,1] neg_hi:[0,1]
    v_pk_add_f32 v[126:127], v[134:135], v[126:127] neg_lo:[0,1] neg_hi:[0,1]
    v_pk_add_f32 v[128:129], v[136:137], v[128:129] neg_lo:[0,1] neg_hi:[0,1]
    v_pk_add_f32 v[130:131], v[138:139], v[130:131] neg_lo:[0,1] neg_hi:[0,1]
    v_cvt_pk_bf16_f32 v108, v124, v125
    v_cvt_pk_bf16_f32 v109, v126, v127
    v_cvt_pk_bf16_f32 v110, v128, v129
    v_cvt_pk_bf16_f32 v111, v130, v131
    v_mfma_f32_16x16x32_bf16 v[56:59], v[104:107], v[96:99], v[56:59]
    v_mfma_f32_16x16x32_bf16 v[56:59], v[104:107], v[100:103], v[56:59]
    v_mfma_f32_16x16x32_bf16 v[56:59], v[108:111], v[96:99], v[56:59]
    ds_read_b128 v[80:83], v8 offset:256
    ds_read_b128 v[84:87], v8 offset:272
    ds_read_b128 v[88:91], v8 offset:288
    ds_read_b128 v[92:95], v8 offset:304
    ds_read_b128 v[116:119], v38 offset:4224
    ds_read_b128 v[120:123], v38 offset:4240
    s_waitcnt lgkmcnt(0)
    v_pk_mul_f32 v[124:125], v[80:81], v[46:47] op_sel_hi:[1,0]
    v_pk_mul_f32 v[126:127], v[84:85], v[46:47] op_sel_hi:[1,0]
    v_pk_mul_f32 v[128:129], v[88:89], v[46:47] op_sel_hi:[1,0]
    v_pk_mul_f32 v[130:131], v[92:93], v[46:47] op_sel_hi:[1,0]
    v_fract_f32 v125, v125
    v_fract_f32 v127, v127
    v_fract_f32 v129, v129
    v_fract_f32 v131, v131
    v_exp_f32 v124, v124
    v_exp_f32 v126, v126
    v_exp_f32 v128, v128
    v_exp_f32 v130, v130
    v_sin_f32 v133, v125
    v_sin_f32 v135, v127
    v_sin_f32 v137, v129
    v_sin_f32 v139, v131
    v_cos_f32 v132, v125
    v_cos_f32 v134, v127
    v_cos_f32 v136, v129
    v_cos_f32 v138, v131
    v_pk_mul_f32 v[132:133], v[132:133], v[124:125] op_sel_hi:[1,0]
    v_pk_mul_f32 v[134:135], v[134:135], v[126:127] op_sel_hi:[1,0]
    v_pk_mul_f32 v[136:137], v[136:137], v[128:129] op_sel_hi:[1,0]
    v_pk_mul_f32 v[138:139], v[138:139], v[130:131] op_sel_hi:[1,0]
    v_pk_mul_f32 v[160:161], v[132:133], v[82:83] op_sel_hi:[1,0] neg_hi:[0,1]
    v_pk_mul_f32 v[162:163], v[134:135], v[86:87] op_sel_hi:[1,0] neg_hi:[0,1]
    v_pk_mul_f32 v[164:165], v[136:137], v[90:91] op_sel_hi:[1,0] neg_hi:[0,1]
    v_pk_mul_f32 v[166:167], v[138:139], v[94:95] op_sel_hi:[1,0] neg_hi:[0,1]
    v_pk_fma_f32 v[160:161], v[132:133], v[82:83], v[160:161] op_sel:[1,1,0] op_sel_hi:[0,1,1] neg_lo:[0,1,0] neg_hi:[0,1,0]
    v_pk_fma_f32 v[162:163], v[134:135], v[86:87], v[162:163] op_sel:[1,1,0] op_sel_hi:[0,1,1] neg_lo:[0,1,0] neg_hi:[0,1,0]
    v_pk_fma_f32 v[164:165], v[136:137], v[90:91], v[164:165] op_sel:[1,1,0] op_sel_hi:[0,1,1] neg_lo:[0,1,0] neg_hi:[0,1,0]
    v_pk_fma_f32 v[166:167], v[138:139], v[94:95], v[166:167] op_sel:[1,1,0] op_sel_hi:[0,1,1] neg_lo:[0,1,0] neg_hi:[0,1,0]
    v_cvt_pk_bf16_f32 v96, v160, v161
    v_cvt_pk_bf16_f32 v97, v162, v163
    v_cvt_pk_bf16_f32 v98, v164, v165
    v_cvt_pk_bf16_f32 v99, v166, v167
    v_lshlrev_b32 v124, 16, v96
    v_and_b32 v125, s23, v96
    v_lshlrev_b32 v126, 16, v97
    v_and_b32 v127, s23, v97
    v_lshlrev_b32 v128, 16, v98
    v_and_b32 v129, s23, v98
    v_lshlrev_b32 v130, 16, v99
    v_and_b32 v131, s23, v99
    v_pk_add_f32 v[124:125], v[160:161], v[124:125] neg_lo:[0,1] neg_hi:[0,1]
    v_pk_add_f32 v[126:127], v[162:163], v[126:127] neg_lo:[0,1] neg_hi:[0,1]
    v_pk_add_f32 v[128:129], v[164:165], v[128:129] neg_lo:[0,1] neg_hi:[0,1]
    v_pk_add_f32 v[130:131], v[166:167], v[130:131] neg_lo:[0,1] neg_hi:[0,1]
    v_cvt_pk_bf16_f32 v100, v124, v125
    v_cvt_pk_bf16_f32 v101, v126, v127
    v_cvt_pk_bf16_f32 v102, v128, v129
    v_cvt_pk_bf16_f32 v103, v130, v131
    v_pk_mul_f32 v[124:125], v[80:81], v[42:43] op_sel_hi:[1,0]
    v_pk_mul_f32 v[126:127], v[84:85], v[42:43] op_sel_hi:[1,0]
    v_pk_mul_f32 v[128:129], v[88:89], v[42:43] op_sel_hi:[1,0]
    v_pk_mul_f32 v[130:131], v[92:93], v[42:43] op_sel_hi:[1,0]
    v_fract_f32 v125, v125
    v_fract_f32 v127, v127
    v_fract_f32 v129, v129
    v_fract_f32 v131, v131
    v_exp_f32 v124, v124
    v_exp_f32 v126, v126
    v_exp_f32 v128, v128
    v_exp_f32 v130, v130
    v_sin_f32 v133, v125
    v_sin_f32 v135, v127
    v_sin_f32 v137, v129
    v_sin_f32 v139, v131
    v_cos_f32 v132, v125
    v_cos_f32 v134, v127
    v_cos_f32 v136, v129
    v_cos_f32 v138, v131
    v_pk_mul_f32 v[132:133], v[132:133], v[124:125] op_sel_hi:[1,0]
    v_pk_mul_f32 v[134:135], v[134:135], v[126:127] op_sel_hi:[1,0]
    v_pk_mul_f32 v[136:137], v[136:137], v[128:129] op_sel_hi:[1,0]
    v_pk_mul_f32 v[138:139], v[138:139], v[130:131] op_sel_hi:[1,0]
    v_cvt_pk_bf16_f32 v104, v132, v133
    v_cvt_pk_bf16_f32 v105, v134, v135
    v_cvt_pk_bf16_f32 v106, v136, v137
    v_cvt_pk_bf16_f32 v107, v138, v139
    v_lshlrev_b32 v124, 16, v104
    v_and_b32 v125, s23, v104
    v_lshlrev_b32 v126, 16, v105
    v_and_b32 v127, s23, v105
    v_lshlrev_b32 v128, 16, v106
    v_and_b32 v129, s23, v106
    v_lshlrev_b32 v130, 16, v107
    v_and_b32 v131, s23, v107
    v_pk_add_f32 v[124:125], v[132:133], v[124:125] neg_lo:[0,1] neg_hi:[0,1]
    v_pk_add_f32 v[126:127], v[134:135], v[126:127] neg_lo:[0,1] neg_hi:[0,1]
    v_pk_add_f32 v[128:129], v[136:137], v[128:129] neg_lo:[0,1] neg_hi:[0,1]
    v_pk_add_f32 v[130:131], v[138:139], v[130:131] neg_lo:[0,1] neg_hi:[0,1]
    v_cvt_pk_bf16_f32 v108, v124, v125
    v_cvt_pk_bf16_f32 v109, v126, v127
    v_cvt_pk_bf16_f32 v110, v128, v129
    v_cvt_pk_bf16_f32 v111, v130, v131
    v_mfma_f32_16x16x32_bf16 v[48:51], v[104:107], v[96:99], v[48:51]
    v_mfma_f32_16x16x32_bf16 v[48:51], v[104:107], v[100:103], v[48:51]
    v_mfma_f32_16x16x32_bf16 v[48:51], v[108:111], v[96:99], v[48:51]
    v_pk_mul_f32 v[160:161], v[132:133], v[116:117] op_sel_hi:[1,0]
    v_pk_mul_f32 v[162:163], v[134:135], v[118:119] op_sel_hi:[1,0]
    v_pk_mul_f32 v[164:165], v[136:137], v[120:121] op_sel_hi:[1,0]
    v_pk_mul_f32 v[166:167], v[138:139], v[122:123] op_sel_hi:[1,0]
    v_pk_fma_f32 v[160:161], v[132:133], v[116:117], v[160:161] op_sel:[1,1,0] op_sel_hi:[0,1,1] neg_lo:[0,1,0]
    v_pk_fma_f32 v[162:163], v[134:135], v[118:119], v[162:163] op_sel:[1,1,0] op_sel_hi:[0,1,1] neg_lo:[0,1,0]
    v_pk_fma_f32 v[164:165], v[136:137], v[120:121], v[164:165] op_sel:[1,1,0] op_sel_hi:[0,1,1] neg_lo:[0,1,0]
    v_pk_fma_f32 v[166:167], v[138:139], v[122:123], v[166:167] op_sel:[1,1,0] op_sel_hi:[0,1,1] neg_lo:[0,1,0]
    v_cvt_pk_bf16_f32 v104, v160, v161
    v_cvt_pk_bf16_f32 v105, v162, v163
    v_cvt_pk_bf16_f32 v106, v164, v165
    v_cvt_pk_bf16_f32 v107, v166, v167
    v_lshlrev_b32 v124, 16, v104
    v_and_b32 v125, s23, v104
    v_lshlrev_b32 v126, 16, v105
    v_and_b32 v127, s23, v105
    v_lshlrev_b32 v128, 16, v106
    v_and_b32 v129, s23, v106
    v_lshlrev_b32 v130, 16, v107
    v_and_b32 v131, s23, v107
    v_pk_add_f32 v[124:125], v[160:161], v[124:125] neg_lo:[0,1] neg_hi:[0,1]
    v_pk_add_f32 v[126:127], v[162:163], v[126:127] neg_lo:[0,1] neg_hi:[0,1]
    v_pk_add_f32 v[128:129], v[164:165], v[128:129] neg_lo:[0,1] neg_hi:[0,1]
    v_pk_add_f32 v[130:131], v[166:167], v[130:131] neg_lo:[0,1] neg_hi:[0,1]
    v_cvt_pk_bf16_f32 v108, v124, v125
    v_cvt_pk_bf16_f32 v109, v126, v127
    v_cvt_pk_bf16_f32 v110, v128, v129
    v_cvt_pk_bf16_f32 v111, v130, v131
    v_mfma_f32_16x16x32_bf16 v[52:55], v[104:107], v[96:99], v[52:55]
    v_mfma_f32_16x16x32_bf16 v[52:55], v[104:107], v[100:103], v[52:55]
    v_mfma_f32_16x16x32_bf16 v[52:55], v[108:111], v[96:99], v[52:55]
    v_pk_mul_f32 v[124:125], v[80:81], v[44:45] op_sel_hi:[1,0]
    v_pk_mul_f32 v[126:127], v[84:85], v[44:45] op_sel_hi:[1,0]
    v_pk_mul_f32 v[128:129], v[88:89], v[44:45] op_sel_hi:[1,0]
    v_pk_mul_f32 v[130:131], v[92:93], v[44:45] op_sel_hi:[1,0]
    v_fract_f32 v125, v125
    v_fract_f32 v127, v127
    v_fract_f32 v129, v129
    v_fract_f32 v131, v131
    v_exp_f32 v124, v124
    v_exp_f32 v126, v126
    v_exp_f32 v128, v128
    v_exp_f32 v130, v130
    v_sin_f32 v133, v125
    v_sin_f32 v135, v127
    v_sin_f32 v137, v129
    v_sin_f32 v139, v131
    v_cos_f32 v132, v125
    v_cos_f32 v134, v127
    v_cos_f32 v136, v129
    v_cos_f32 v138, v131
    v_pk_mul_f32 v[132:133], v[132:133], v[124:125] op_sel_hi:[1,0]
    v_pk_mul_f32 v[134:135], v[134:135], v[126:127] op_sel_hi:[1,0]
    v_pk_mul_f32 v[136:137], v[136:137], v[128:129] op_sel_hi:[1,0]
    v_pk_mul_f32 v[138:139], v[138:139], v[130:131] op_sel_hi:[1,0]
    v_cvt_pk_bf16_f32 v104, v132, v133
    v_cvt_pk_bf16_f32 v105, v134, v135
    v_cvt_pk_bf16_f32 v106, v136, v137
    v_cvt_pk_bf16_f32 v107, v138, v139
    v_lshlrev_b32 v124, 16, v104
    v_and_b32 v125, s23, v104
    v_lshlrev_b32 v126, 16, v105
    v_and_b32 v127, s23, v105
    v_lshlrev_b32 v128, 16, v106
    v_and_b32 v129, s23, v106
    v_lshlrev_b32 v130, 16, v107
    v_and_b32 v131, s23, v107
    v_pk_add_f32 v[124:125], v[132:133], v[124:125] neg_lo:[0,1] neg_hi:[0,1]
    v_pk_add_f32 v[126:127], v[134:135], v[126:127] neg_lo:[0,1] neg_hi:[0,1]
    v_pk_add_f32 v[128:129], v[136:137], v[128:129] neg_lo:[0,1] neg_hi:[0,1]
    v_pk_add_f32 v[130:131], v[138:139], v[130:131] neg_lo:[0,1] neg_hi:[0,1]
    v_cvt_pk_bf16_f32 v108, v124, v125
    v_cvt_pk_bf16_f32 v109, v126, v127
    v_cvt_pk_bf16_f32 v110, v128, v129
    v_cvt_pk_bf16_f32 v111, v130, v131
    v_mfma_f32_16x16x32_bf16 v[56:59], v[104:107], v[96:99], v[56:59]
    v_mfma_f32_16x16x32_bf16 v[56:59], v[104:107], v[100:103], v[56:59]
    v_mfma_f32_16x16x32_bf16 v[56:59], v[108:111], v[96:99], v[56:59]
    ds_write_b128 v47, v[48:51] offset:0
    ds_write_b128 v47, v[52:55] offset:1024
    s_nop 5
    ds_write_b128 v47, v[56:59] offset:2048
    s_mul_i32 s11, s9, 12288
    s_add_u32 s11, s11, 6208
    v_lshlrev_b32 v24, 2, v5
    v_add_u32 v24, s11, v24
    s_mul_i32 s12, s9, 8448
    s_add_u32 s12, s12, 30848
    v_bfe_u32 v25, v5, 2, 4
    v_lshrrev_b32 v26, 6, v5
    v_and_b32 v27, 3, v5
    v_lshlrev_b32 v28, 7, v25
    v_add_u32 v28, s12, v28
    v_lshl_add_u32 v29, v26, 5, v28
    v_lshl_add_u32 v29, v27, 3, v29
    v_lshlrev_b32 v30, 6, v26
    v_lshl_add_u32 v30, v27, 4, v30
    v_add_u32 v30, 0x800, v30
    v_and_b32 v31, 1, v26
    v_lshlrev_b32 v31, 11, v31
    v_lshl_add_u32 v31, v27, 5, v31
    v_add_u32 v31, 0x1000, v31
    v_cmp_gt_u32 vcc, 2, v26
    s_nop 1
    v_cndmask_b32 v30, v31, v30, vcc
    v_add_u32 v30, v30, v28
    s_lshl_b32 s13, s9, 4
    v_mov_b32 v31, s13
    s_cmp_lg_u32 s8, 0
    s_cbranch_scc1 K2_NOPOLL
    v_and_b32 v36, 3, v2
    v_lshlrev_b32 v36, 6, v36
    s_mov_b32 s3, 0
K2_POLL:
    global_load_dword v37, v36, s[48:49] sc1
    s_waitcnt vmcnt(0)
    v_cmp_gt_u32 vcc, 64, v37
    s_add_u32 s3, s3, 1
    s_cmp_eq_u64 vcc, 0
    s_cbranch_scc1 K2_NOPOLL
    s_sleep 2
    s_cmp_lt_u32 s3, 0x8000
    s_cbranch_scc1 K2_POLL
K2_NOPOLL:
    s_waitcnt lgkmcnt(0)
    s_barrier
    v_lshlrev_b32 v36, 5, v0
    global_load_dwordx4 v[148:151], v36, s[36:37] sc1
    global_load_dwordx4 v[152:155], v36, s[36:37] offset:16 sc1
    ds_read_b32 v48, v24 offset:0
    ds_read_b32 v49, v24 offset:3072
    ds_read_b32 v50, v24 offset:6144
    ds_read_b32 v51, v24 offset:9216
    ds_read_b32 v52, v24 offset:1024
    ds_read_b32 v53, v24 offset:4096
    ds_read_b32 v54, v24 offset:7168
    ds_read_b32 v55, v24 offset:10240
    ds_read_b32 v56, v24 offset:2048
    ds_read_b32 v57, v24 offset:5120
    ds_read_b32 v58, v24 offset:8192
    ds_read_b32 v59, v24 offset:11264
    ds_read_b128 v[60:63], v31 offset:30784
    s_waitcnt lgkmcnt(0)
    v_add_f32 v48, v48, v49
    v_add_f32 v50, v50, v51
    v_add_f32 v48, v48, v50
    v_add_f32 v52, v52, v53
    v_add_f32 v54, v54, v55
    v_add_f32 v52, v52, v54
    v_add_f32 v56, v56, v57
    v_add_f32 v58, v58, v59
    v_add_f32 v56, v56, v58
    v_add_f32 v60, v60, v61
    v_add_f32 v62, v62, v63
    v_add_f32 v60, v60, v62
    ds_write2_b32 v29, v48, v52 offset0:0 offset1:1
    ds_write_b32 v30, v56
    v_mov_b32 v31, s12
    ds_write_b32 v31, v60 offset:8192
    v_cvt_pk_bf16_f32 v61, v48, 0
    v_lshlrev_b32 v62, 16, v61
    v_sub_f32 v62, v48, v62
    v_cvt_pk_bf16_f32 v62, v62, 0
    s_mul_i32 s3, s9, 10240
    s_add_u32 s3, s3, 51904
    v_mov_b32 v31, s3
    v_cmp_eq_u32 vcc, 0, v5
    s_and_saveexec_b64 s[42:43], vcc
    ds_write_b32 v31, v61
    ds_write_b32 v31, v62 offset:5120
    s_mov_b64 exec, s[42:43]
    s_waitcnt lgkmcnt(0)
    s_barrier
    s_mul_i32 s3, s9, 10240
    s_add_u32 s3, s3, 47808
    v_lshlrev_b32 v25, 4, v5
    v_add_u32 v25, s3, v25
    v_lshlrev_b32 v1, 3, v5
    v_sub_u32 v1, 0x800, v1
    v_subrev_u32 v60, 0, v1
    v_cvt_f32_u32 v60, v60
    v_subrev_u32 v61, 1, v1
    v_cvt_f32_u32 v61, v61
    v_subrev_u32 v62, 2, v1
    v_cvt_f32_u32 v62, v62
    v_subrev_u32 v63, 3, v1
    v_cvt_f32_u32 v63, v63
    v_subrev_u32 v64, 4, v1
    v_cvt_f32_u32 v64, v64
    v_subrev_u32 v65, 5, v1
    v_cvt_f32_u32 v65, v65
    v_subrev_u32 v66, 6, v1
    v_cvt_f32_u32 v66, v66
    v_subrev_u32 v67, 7, v1
    v_cvt_f32_u32 v67, v67
    v_cvt_pk_bf16_f32 v70, v60, v61
    v_cvt_pk_bf16_f32 v71, v62, v63
    v_cvt_pk_bf16_f32 v72, v64, v65
    v_cvt_pk_bf16_f32 v73, v66, v67
    v_lshlrev_b32 v60, 16, v70
    v_and_b32 v61, s23, v70
    v_lshlrev_b32 v62, 16, v71
    v_and_b32 v63, s23, v71
    v_lshlrev_b32 v64, 16, v72
    v_and_b32 v65, s23, v72
    v_lshlrev_b32 v66, 16, v73
    v_and_b32 v67, s23, v73
    v_cvt_u32_f32 v60, v60
    v_lshl_add_u32 v60, v60, 2, s12
    ds_read_b32 v70, v60
    v_cvt_u32_f32 v61, v61
    v_lshl_add_u32 v61, v61, 2, s12
    ds_read_b32 v71, v61
    v_cvt_u32_f32 v62, v62
    v_lshl_add_u32 v62, v62, 2, s12
    ds_read_b32 v72, v62
    v_cvt_u32_f32 v63, v63
    v_lshl_add_u32 v63, v63, 2, s12
    ds_read_b32 v73, v63
    v_cvt_u32_f32 v64, v64
    v_lshl_add_u32 v64, v64, 2, s12
    ds_read_b32 v74, v64
    v_cvt_u32_f32 v65, v65
    v_lshl_add_u32 v65, v65, 2, s12
    ds_read_b32 v75, v65
    v_cvt_u32_f32 v66, v66
    v_lshl_add_u32 v66, v66, 2, s12
    ds_read_b32 v76, v66
    v_cvt_u32_f32 v67, v67
    v_lshl_add_u32 v67, v67, 2, s12
    ds_read_b32 v77, v67
    v_cmp_ne_u32 vcc, 0, v5
    s_waitcnt lgkmcnt(0)
    s_nop 0
    v_cndmask_b32 v70, 0, v70, vcc
    v_cvt_pk_bf16_f32 v80, v70, v71
    v_lshlrev_b32 v60, 16, v80
    v_and_b32 v61, s23, v80
    v_pk_add_f32 v[60:61], v[70:71], v[60:61] neg_lo:[0,1] neg_hi:[0,1]
    v_cvt_pk_bf16_f32 v84, v60, v61
    v_cvt_pk_bf16_f32 v81, v72, v73
    v_lshlrev_b32 v60, 16, v81
    v_and_b32 v61, s23, v81
    v_pk_add_f32 v[60:61], v[72:73], v[60:61] neg_lo:[0,1] neg_hi:[0,1]
    v_cvt_pk_bf16_f32 v85, v60, v61
    v_cvt_pk_bf16_f32 v82, v74, v75
    v_lshlrev_b32 v60, 16, v82
    v_and_b32 v61, s23, v82
    v_pk_add_f32 v[60:61], v[74:75], v[60:61] neg_lo:[0,1] neg_hi:[0,1]
    v_cvt_pk_bf16_f32 v86, v60, v61
    v_cvt_pk_bf16_f32 v83, v76, v77
    v_lshlrev_b32 v60, 16, v83
    v_and_b32 v61, s23, v83
    v_pk_add_f32 v[60:61], v[76:77], v[60:61] neg_lo:[0,1] neg_hi:[0,1]
    v_cvt_pk_bf16_f32 v87, v60, v61
    ds_write_b128 v25, v[80:83]
    ds_write_b128 v25, v[84:87] offset:5120
    s_waitcnt vmcnt(0)
    v_rcp_f32 v64, v149
    v_lshlrev_b32 v66, 16, v144
    v_and_b32 v70, s23, v144
    v_sub_f32 v66, v66, v148
    v_cvt_pk_bf16_f32 v66, v66, v66
    v_lshlrev_b32 v66, 16, v66
    v_mul_f32 v65, v66, v64
    v_fma_f32 v74, -v65, v149, v66
    v_fma_f32 v66, v74, v64, v65
    v_sub_f32 v70, v70, v148
    v_cvt_pk_bf16_f32 v70, v70, v70
    v_lshlrev_b32 v70, 16, v70
    v_mul_f32 v65, v70, v64
    v_fma_f32 v74, -v65, v149, v70
    v_fma_f32 v70, v74, v64, v65
    v_rcp_f32 v64, v151
    v_lshlrev_b32 v67, 16, v145
    v_and_b32 v71, s23, v145
    v_sub_f32 v67, v67, v150
    v_cvt_pk_bf16_f32 v67, v67, v67
    v_lshlrev_b32 v67, 16, v67
    v_mul_f32 v65, v67, v64
    v_fma_f32 v74, -v65, v151, v67
    v_fma_f32 v67, v74, v64, v65
    v_sub_f32 v71, v71, v150
    v_cvt_pk_bf16_f32 v71, v71, v71
    v_lshlrev_b32 v71, 16, v71
    v_mul_f32 v65, v71, v64
    v_fma_f32 v74, -v65, v151, v71
    v_fma_f32 v71, v74, v64, v65
    v_rcp_f32 v64, v153
    v_lshlrev_b32 v68, 16, v146
    v_and_b32 v72, s23, v146
    v_sub_f32 v68, v68, v152
    v_cvt_pk_bf16_f32 v68, v68, v68
    v_lshlrev_b32 v68, 16, v68
    v_mul_f32 v65, v68, v64
    v_fma_f32 v74, -v65, v153, v68
    v_fma_f32 v68, v74, v64, v65
    v_sub_f32 v72, v72, v152
    v_cvt_pk_bf16_f32 v72, v72, v72
    v_lshlrev_b32 v72, 16, v72
    v_mul_f32 v65, v72, v64
    v_fma_f32 v74, -v65, v153, v72
    v_fma_f32 v72, v74, v64, v65
    v_rcp_f32 v64, v155
    v_lshlrev_b32 v69, 16, v147
    v_and_b32 v73, s23, v147
    v_sub_f32 v69, v69, v154
    v_cvt_pk_bf16_f32 v69, v69, v69
    v_lshlrev_b32 v69, 16, v69
    v_mul_f32 v65, v69, v64
    v_fma_f32 v74, -v65, v155, v69
    v_fma_f32 v69, v74, v64, v65
    v_sub_f32 v73, v73, v154
    v_cvt_pk_bf16_f32 v73, v73, v73
    v_lshlrev_b32 v73, 16, v73
    v_mul_f32 v65, v73, v64
    v_fma_f32 v74, -v65, v155, v73
    v_fma_f32 v73, v74, v64, v65
    v_cvt_pk_bf16_f32 v76, v66, v67
    v_cvt_pk_bf16_f32 v77, v68, v69
    v_cvt_pk_bf16_f32 v78, v70, v71
    v_cvt_pk_bf16_f32 v79, v72, v73
    s_mov_b32 s13, 0x05040100
    s_mov_b32 s14, 0x07060302
    v_perm_b32 v80, v145, v144, s13
    v_perm_b32 v81, v147, v146, s13
    v_perm_b32 v82, v145, v144, s14
    v_perm_b32 v83, v147, v146, s14
    v_lshlrev_b32 v1, 3, v0
    v_add_u32 v36, 68288, v1
    ds_write_b64 v36, v[76:77]
    ds_write_b64 v36, v[78:79] offset:34304
    v_add_u32 v36, 6208, v1
    ds_write_b64 v36, v[80:81]
    ds_write_b64 v36, v[82:83] offset:4096
    v_mov_b32 v88, 0
    v_mov_b32 v89, 0
    v_mov_b32 v90, 0
    v_mov_b32 v91, 0
    v_and_b32 v36, 15, v0
    v_lshlrev_b32 v36, 4, v36
    v_add_u32 v37, 0x1000, v36
    v_cmp_gt_u32 vcc, 64, v36
    s_nop 1
    v_cndmask_b32 v36, v37, v36, vcc
    v_bfe_u32 v37, v0, 4, 1
    v_mul_u32_u24 v37, 34304, v37
    v_add3_u32 v36, v36, v37, 0
    v_add_u32 v36, 68224, v36
    v_and_b32 v37, 15, v0
    v_cmp_gt_u32 vcc, 12, v37
    v_cmp_gt_u32 s[42:43], 32, v0
    s_and_b64 vcc, vcc, s[42:43]
    s_and_saveexec_b64 s[42:43], vcc
    ds_write_b128 v36, v[88:91]
    s_mov_b64 exec, s[42:43]
    s_cmp_lg_u32 s2, 0
    s_cbranch_scc1 K2_NOZ
    v_lshlrev_b32 v84, 4, v0
    v_add_u32 v85, 16779264, v84
    v_add_u32 v84, 18876416, v84
    v_cmp_gt_u32 vcc, 128, v0
    s_nop 1
    v_cndmask_b32 v84, v84, v85, vcc
    v_cmp_gt_u32 vcc, 256, v0
    s_and_saveexec_b64 s[42:43], vcc
    global_store_dwordx4 v84, v[88:91], s[32:33] sc1
    s_mov_b64 exec, s[42:43]
K2_NOZ:
    s_waitcnt lgkmcnt(0)
    s_barrier
    ds_read_b128 v[144:147], v7
    ds_read_b128 v[148:151], v7 offset:16
    ds_read_b128 v[152:155], v7 offset:4096
    ds_read_b128 v[156:159], v7 offset:4112
    s_lshl_b32 s3, s9, 12
    s_lshl_b32 s6, s10, 10
    s_add_u32 s3, s3, s6
    v_add_u32 v36, s3, v11
    ds_read_b64 v[16:17], v36 offset:6208
    ds_read_b64 v[18:19], v36 offset:6720
    ds_read_b64 v[20:21], v15 offset:64
    ds_read_b64 v[22:23], v15 offset:576
    s_waitcnt lgkmcnt(0)
    v_alignbit_b32 v88, v145, v144, 16
    v_alignbit_b32 v89, v146, v145, 16
    v_alignbit_b32 v90, v147, v146, 16
    v_alignbit_b32 v91, v148, v147, 16
    ds_write_b128 v7, v[88:91] offset:4288
    v_mov_b32 v24, v145
    v_mov_b32 v25, v146
    v_mov_b32 v26, v147
    v_mov_b32 v27, v148
    ds_write_b128 v7, v[24:27] offset:8576
    v_alignbit_b32 v28, v146, v145, 16
    v_alignbit_b32 v29, v147, v146, 16
    v_alignbit_b32 v30, v148, v147, 16
    v_alignbit_b32 v31, v149, v148, 16
    ds_write_b128 v7, v[28:31] offset:12864
    ds_write_b128 v7, v[146:149] offset:17152
    v_alignbit_b32 v88, v147, v146, 16
    v_alignbit_b32 v89, v148, v147, 16
    v_alignbit_b32 v90, v149, v148, 16
    v_alignbit_b32 v91, v150, v149, 16
    ds_write_b128 v7, v[88:91] offset:21440
    v_mov_b32 v24, v147
    v_mov_b32 v25, v148
    v_mov_b32 v26, v149
    v_mov_b32 v27, v150
    ds_write_b128 v7, v[24:27] offset:25728
    v_alignbit_b32 v28, v148, v147, 16
    v_alignbit_b32 v29, v149, v148, 16
    v_alignbit_b32 v30, v150, v149, 16
    v_alignbit_b32 v31, v151, v150, 16
    ds_write_b128 v7, v[28:31] offset:30016
    v_cmp_gt_u32 vcc, 8, v5
    s_and_saveexec_b64 s[42:43], vcc
    s_cbranch_execz K2_CP_DONE
    v_alignbit_b32 v88, v153, v152, 16
    v_alignbit_b32 v89, v154, v153, 16
    v_alignbit_b32 v90, v155, v154, 16
    v_alignbit_b32 v91, v156, v155, 16
    ds_write_b128 v7, v[88:91] offset:8384
    v_mov_b32 v24, v153
    v_mov_b32 v25, v154
    v_mov_b32 v26, v155
    v_mov_b32 v27, v156
    ds_write_b128 v7, v[24:27] offset:12672
    v_alignbit_b32 v28, v154, v153, 16
    v_alignbit_b32 v29, v155, v154, 16
    v_alignbit_b32 v30, v156, v155, 16
    v_alignbit_b32 v31, v157, v156, 16
    ds_write_b128 v7, v[28:31] offset:16960
    ds_write_b128 v7, v[154:157] offset:21248
    v_alignbit_b32 v88, v155, v154, 16
    v_alignbit_b32 v89, v156, v155, 16
    v_alignbit_b32 v90, v157, v156, 16
    v_alignbit_b32 v91, v158, v157, 16
    ds_write_b128 v7, v[88:91] offset:25536
    v_mov_b32 v24, v155
    v_mov_b32 v25, v156
    v_mov_b32 v26, v157
    v_mov_b32 v27, v158
    ds_write_b128 v7, v[24:27] offset:29824
    v_alignbit_b32 v28, v156, v155, 16
    v_alignbit_b32 v29, v157, v156, 16
    v_alignbit_b32 v30, v158, v157, 16
    v_alignbit_b32 v31, v159, v158, 16
    ds_write_b128 v7, v[28:31] offset:34112
K2_CP_DONE:
    s_mov_b64 exec, s[42:43]
    v_and_b32 v13, 7, v9
    v_mul_u32_u24 v13, 4288, v13
    v_and_b32 v14, 8, v9
    v_lshl_add_u32 v14, v10, 3, v14
    v_lshl_add_u32 v13, v14, 1, v13
    s_mul_i32 s4, s9, 34304
    s_add_u32 s4, s4, 68224
    v_add_u32 v13, s4, v13
    v_lshlrev_b32 v14, 5, v9
    v_sub_u32 v14, 480, v14
    v_lshl_add_u32 v14, v10, 4, v14
    s_mul_i32 s5, s9, 10240
    s_add_u32 s5, s5, 47744
    v_add_u32 v14, s5, v14
    v_mov_b32 v32, 0
    v_mov_b32 v33, 0
    v_mov_b32 v34, 0
    v_mov_b32 v35, 0
    v_mov_b32 v36, 0
    v_mov_b32 v37, 0
    v_mov_b32 v38, 0
    v_mov_b32 v39, 0
    v_mov_b32 v40, 0
    v_mov_b32 v41, 0
    v_mov_b32 v42, 0
    v_mov_b32 v43, 0
    v_mov_b32 v44, 0
    v_mov_b32 v45, 0
    v_mov_b32 v46, 0
    v_mov_b32 v47, 0
    v_mov_b32 v48, 0
    v_mov_b32 v49, 0
    v_mov_b32 v50, 0
    v_mov_b32 v51, 0
    v_mov_b32 v52, 0
    v_mov_b32 v53, 0
    v_mov_b32 v54, 0
    v_mov_b32 v55, 0
    v_mov_b32 v56, 0
    v_mov_b32 v57, 0
    v_mov_b32 v58, 0
    v_mov_b32 v59, 0
    v_mov_b32 v60, 0
    v_mov_b32 v61, 0
    v_mov_b32 v62, 0
    v_mov_b32 v63, 0
    s_waitcnt lgkmcnt(0)
    s_barrier
    s_cmp_lg_u32 s10, 0
    s_cbranch_scc1 K2_GEN
    ds_read_b128 v[104:107], v14 offset:3680
    ds_read_b128 v[140:143], v14 offset:8800
    ds_read_b128 v[108:111], v14 offset:3168
    ds_read_b128 v[144:147], v14 offset:8288
    ds_read_b128 v[112:115], v14 offset:2656
    ds_read_b128 v[148:151], v14 offset:7776
    ds_read_b128 v[116:119], v14 offset:2144
    ds_read_b128 v[152:155], v14 offset:7264
    ds_read_b128 v[120:123], v14 offset:1632
    ds_read_b128 v[156:159], v14 offset:6752
    ds_read_b128 v[124:127], v14 offset:1120
    ds_read_b128 v[160:163], v14 offset:6240
    ds_read_b128 v[128:131], v14 offset:608
    ds_read_b128 v[164:167], v14 offset:5728
    ds_read_b128 v[132:135], v14 offset:96
    ds_read_b128 v[168:171], v14 offset:5216
    ds_read_b128 v[64:67], v13 offset:64
    ds_read_b128 v[68:71], v13 offset:576
    ds_read_b128 v[72:75], v13 offset:1088
    ds_read_b128 v[76:79], v13 offset:1600
    ds_read_b128 v[80:83], v13 offset:2112
    ds_read_b128 v[84:87], v13 offset:2624
    ds_read_b128 v[88:91], v13 offset:3136
    ds_read_b128 v[92:95], v13 offset:3648
    s_waitcnt lgkmcnt(7)
    v_mfma_f32_16x16x32_bf16 v[32:35], v[64:67], v[104:107], v[32:35]
    v_mfma_f32_16x16x32_bf16 v[32:35], v[64:67], v[140:143], v[32:35]
    v_mfma_f32_16x16x32_bf16 v[36:39], v[64:67], v[108:111], v[36:39]
    v_mfma_f32_16x16x32_bf16 v[36:39], v[64:67], v[144:147], v[36:39]
    v_mfma_f32_16x16x32_bf16 v[40:43], v[64:67], v[112:115], v[40:43]
    v_mfma_f32_16x16x32_bf16 v[40:43], v[64:67], v[148:151], v[40:43]
    v_mfma_f32_16x16x32_bf16 v[44:47], v[64:67], v[116:119], v[44:47]
    v_mfma_f32_16x16x32_bf16 v[44:47], v[64:67], v[152:155], v[44:47]
    v_mfma_f32_16x16x32_bf16 v[48:51], v[64:67], v[120:123], v[48:51]
    v_mfma_f32_16x16x32_bf16 v[48:51], v[64:67], v[156:159], v[48:51]
    v_mfma_f32_16x16x32_bf16 v[52:55], v[64:67], v[124:127], v[52:55]
    v_mfma_f32_16x16x32_bf16 v[52:55], v[64:67], v[160:163], v[52:55]
    v_mfma_f32_16x16x32_bf16 v[56:59], v[64:67], v[128:131], v[56:59]
    v_mfma_f32_16x16x32_bf16 v[56:59], v[64:67], v[164:167], v[56:59]
    v_mfma_f32_16x16x32_bf16 v[60:63], v[64:67], v[132:135], v[60:63]
    v_mfma_f32_16x16x32_bf16 v[60:63], v[64:67], v[168:171], v[60:63]
    s_waitcnt lgkmcnt(6)
    v_mfma_f32_16x16x32_bf16 v[36:39], v[68:71], v[104:107], v[36:39]
    v_mfma_f32_16x16x32_bf16 v[36:39], v[68:71], v[140:143], v[36:39]
    v_mfma_f32_16x16x32_bf16 v[40:43], v[68:71], v[108:111], v[40:43]
    v_mfma_f32_16x16x32_bf16 v[40:43], v[68:71], v[144:147], v[40:43]
    v_mfma_f32_16x16x32_bf16 v[44:47], v[68:71], v[112:115], v[44:47]
    v_mfma_f32_16x16x32_bf16 v[44:47], v[68:71], v[148:151], v[44:47]
    v_mfma_f32_16x16x32_bf16 v[48:51], v[68:71], v[116:119], v[48:51]
    v_mfma_f32_16x16x32_bf16 v[48:51], v[68:71], v[152:155], v[48:51]
    v_mfma_f32_16x16x32_bf16 v[52:55], v[68:71], v[120:123], v[52:55]
    v_mfma_f32_16x16x32_bf16 v[52:55], v[68:71], v[156:159], v[52:55]
    v_mfma_f32_16x16x32_bf16 v[56:59], v[68:71], v[124:127], v[56:59]
    v_mfma_f32_16x16x32_bf16 v[56:59], v[68:71], v[160:163], v[56:59]
    v_mfma_f32_16x16x32_bf16 v[60:63], v[68:71], v[128:131], v[60:63]
    v_mfma_f32_16x16x32_bf16 v[60:63], v[68:71], v[164:167], v[60:63]
    s_waitcnt lgkmcnt(5)
    v_mfma_f32_16x16x32_bf16 v[40:43], v[72:75], v[104:107], v[40:43]
    v_mfma_f32_16x16x32_bf16 v[40:43], v[72:75], v[140:143], v[40:43]
    v_mfma_f32_16x16x32_bf16 v[44:47], v[72:75], v[108:111], v[44:47]
    v_mfma_f32_16x16x32_bf16 v[44:47], v[72:75], v[144:147], v[44:47]
    v_mfma_f32_16x16x32_bf16 v[48:51], v[72:75], v[112:115], v[48:51]
    v_mfma_f32_16x16x32_bf16 v[48:51], v[72:75], v[148:151], v[48:51]
    v_mfma_f32_16x16x32_bf16 v[52:55], v[72:75], v[116:119], v[52:55]
    v_mfma_f32_16x16x32_bf16 v[52:55], v[72:75], v[152:155], v[52:55]
    v_mfma_f32_16x16x32_bf16 v[56:59], v[72:75], v[120:123], v[56:59]
    v_mfma_f32_16x16x32_bf16 v[56:59], v[72:75], v[156:159], v[56:59]
    v_mfma_f32_16x16x32_bf16 v[60:63], v[72:75], v[124:127], v[60:63]
    v_mfma_f32_16x16x32_bf16 v[60:63], v[72:75], v[160:163], v[60:63]
    s_waitcnt lgkmcnt(4)
    v_mfma_f32_16x16x32_bf16 v[44:47], v[76:79], v[104:107], v[44:47]
    v_mfma_f32_16x16x32_bf16 v[44:47], v[76:79], v[140:143], v[44:47]
    v_mfma_f32_16x16x32_bf16 v[48:51], v[76:79], v[108:111], v[48:51]
    v_mfma_f32_16x16x32_bf16 v[48:51], v[76:79], v[144:147], v[48:51]
    v_mfma_f32_16x16x32_bf16 v[52:55], v[76:79], v[112:115], v[52:55]
    v_mfma_f32_16x16x32_bf16 v[52:55], v[76:79], v[148:151], v[52:55]
    v_mfma_f32_16x16x32_bf16 v[56:59], v[76:79], v[116:119], v[56:59]
    v_mfma_f32_16x16x32_bf16 v[56:59], v[76:79], v[152:155], v[56:59]
    v_mfma_f32_16x16x32_bf16 v[60:63], v[76:79], v[120:123], v[60:63]
    v_mfma_f32_16x16x32_bf16 v[60:63], v[76:79], v[156:159], v[60:63]
    s_waitcnt lgkmcnt(3)
    v_mfma_f32_16x16x32_bf16 v[48:51], v[80:83], v[104:107], v[48:51]
    v_mfma_f32_16x16x32_bf16 v[48:51], v[80:83], v[140:143], v[48:51]
    v_mfma_f32_16x16x32_bf16 v[52:55], v[80:83], v[108:111], v[52:55]
    v_mfma_f32_16x16x32_bf16 v[52:55], v[80:83], v[144:147], v[52:55]
    v_mfma_f32_16x16x32_bf16 v[56:59], v[80:83], v[112:115], v[56:59]
    v_mfma_f32_16x16x32_bf16 v[56:59], v[80:83], v[148:151], v[56:59]
    v_mfma_f32_16x16x32_bf16 v[60:63], v[80:83], v[116:119], v[60:63]
    v_mfma_f32_16x16x32_bf16 v[60:63], v[80:83], v[152:155], v[60:63]
    s_waitcnt lgkmcnt(2)
    v_mfma_f32_16x16x32_bf16 v[52:55], v[84:87], v[104:107], v[52:55]
    v_mfma_f32_16x16x32_bf16 v[52:55], v[84:87], v[140:143], v[52:55]
    v_mfma_f32_16x16x32_bf16 v[56:59], v[84:87], v[108:111], v[56:59]
    v_mfma_f32_16x16x32_bf16 v[56:59], v[84:87], v[144:147], v[56:59]
    v_mfma_f32_16x16x32_bf16 v[60:63], v[84:87], v[112:115], v[60:63]
    v_mfma_f32_16x16x32_bf16 v[60:63], v[84:87], v[148:151], v[60:63]
    s_waitcnt lgkmcnt(1)
    v_mfma_f32_16x16x32_bf16 v[56:59], v[88:91], v[104:107], v[56:59]
    v_mfma_f32_16x16x32_bf16 v[56:59], v[88:91], v[140:143], v[56:59]
    v_mfma_f32_16x16x32_bf16 v[60:63], v[88:91], v[108:111], v[60:63]
    v_mfma_f32_16x16x32_bf16 v[60:63], v[88:91], v[144:147], v[60:63]
    s_waitcnt lgkmcnt(0)
    v_mfma_f32_16x16x32_bf16 v[60:63], v[92:95], v[104:107], v[60:63]
    v_mfma_f32_16x16x32_bf16 v[60:63], v[92:95], v[140:143], v[60:63]
    ds_read_b128 v[100:103], v14 offset:4128
    ds_read_b128 v[136:139], v14 offset:9248
    ds_read_b128 v[104:107], v14 offset:3616
    ds_read_b128 v[140:143], v14 offset:8736
    ds_read_b128 v[108:111], v14 offset:3104
    ds_read_b128 v[144:147], v14 offset:8224
    ds_read_b128 v[112:115], v14 offset:2592
    ds_read_b128 v[148:151], v14 offset:7712
    ds_read_b128 v[116:119], v14 offset:2080
    ds_read_b128 v[152:155], v14 offset:7200
    ds_read_b128 v[120:123], v14 offset:1568
    ds_read_b128 v[156:159], v14 offset:6688
    ds_read_b128 v[124:127], v14 offset:1056
    ds_read_b128 v[160:163], v14 offset:6176
    ds_read_b128 v[128:131], v14 offset:544
    ds_read_b128 v[164:167], v14 offset:5664
    ds_read_b128 v[132:135], v14 offset:32
    ds_read_b128 v[168:171], v14 offset:5152
    ds_read_b128 v[64:67], v13 offset:0
    ds_read_b128 v[68:71], v13 offset:512
    ds_read_b128 v[72:75], v13 offset:1024
    ds_read_b128 v[76:79], v13 offset:1536
    ds_read_b128 v[80:83], v13 offset:2048
    ds_read_b128 v[84:87], v13 offset:2560
    ds_read_b128 v[88:91], v13 offset:3072
    ds_read_b128 v[92:95], v13 offset:3584
    ds_read_b128 v[96:99], v13 offset:4096
    s_waitcnt lgkmcnt(8)
    v_mfma_f32_16x16x32_bf16 v[32:35], v[64:67], v[104:107], v[32:35]
    v_mfma_f32_16x16x32_bf16 v[32:35], v[64:67], v[140:143], v[32:35]
    v_mfma_f32_16x16x32_bf16 v[36:39], v[64:67], v[108:111], v[36:39]
    v_mfma_f32_16x16x32_bf16 v[36:39], v[64:67], v[144:147], v[36:39]
    v_mfma_f32_16x16x32_bf16 v[40:43], v[64:67], v[112:115], v[40:43]
    v_mfma_f32_16x16x32_bf16 v[40:43], v[64:67], v[148:151], v[40:43]
    v_mfma_f32_16x16x32_bf16 v[44:47], v[64:67], v[116:119], v[44:47]
    v_mfma_f32_16x16x32_bf16 v[44:47], v[64:67], v[152:155], v[44:47]
    v_mfma_f32_16x16x32_bf16 v[48:51], v[64:67], v[120:123], v[48:51]
    v_mfma_f32_16x16x32_bf16 v[48:51], v[64:67], v[156:159], v[48:51]
    v_mfma_f32_16x16x32_bf16 v[52:55], v[64:67], v[124:127], v[52:55]
    v_mfma_f32_16x16x32_bf16 v[52:55], v[64:67], v[160:163], v[52:55]
    v_mfma_f32_16x16x32_bf16 v[56:59], v[64:67], v[128:131], v[56:59]
    v_mfma_f32_16x16x32_bf16 v[56:59], v[64:67], v[164:167], v[56:59]
    v_mfma_f32_16x16x32_bf16 v[60:63], v[64:67], v[132:135], v[60:63]
    v_mfma_f32_16x16x32_bf16 v[60:63], v[64:67], v[168:171], v[60:63]
    s_waitcnt lgkmcnt(7)
    v_mfma_f32_16x16x32_bf16 v[32:35], v[68:71], v[100:103], v[32:35]
    v_mfma_f32_16x16x32_bf16 v[32:35], v[68:71], v[136:139], v[32:35]
    v_mfma_f32_16x16x32_bf16 v[36:39], v[68:71], v[104:107], v[36:39]
    v_mfma_f32_16x16x32_bf16 v[36:39], v[68:71], v[140:143], v[36:39]
    v_mfma_f32_16x16x32_bf16 v[40:43], v[68:71], v[108:111], v[40:43]
    v_mfma_f32_16x16x32_bf16 v[40:43], v[68:71], v[144:147], v[40:43]
    v_mfma_f32_16x16x32_bf16 v[44:47], v[68:71], v[112:115], v[44:47]
    v_mfma_f32_16x16x32_bf16 v[44:47], v[68:71], v[148:151], v[44:47]
    v_mfma_f32_16x16x32_bf16 v[48:51], v[68:71], v[116:119], v[48:51]
    v_mfma_f32_16x16x32_bf16 v[48:51], v[68:71], v[152:155], v[48:51]
    v_mfma_f32_16x16x32_bf16 v[52:55], v[68:71], v[120:123], v[52:55]
    v_mfma_f32_16x16x32_bf16 v[52:55], v[68:71], v[156:159], v[52:55]
    v_mfma_f32_16x16x32_bf16 v[56:59], v[68:71], v[124:127], v[56:59]
    v_mfma_f32_16x16x32_bf16 v[56:59], v[68:71], v[160:163], v[56:59]
    v_mfma_f32_16x16x32_bf16 v[60:63], v[68:71], v[128:131], v[60:63]
    v_mfma_f32_16x16x32_bf16 v[60:63], v[68:71], v[164:167], v[60:63]
    s_waitcnt lgkmcnt(6)
    v_mfma_f32_16x16x32_bf16 v[36:39], v[72:75], v[100:103], v[36:39]
    v_mfma_f32_16x16x32_bf16 v[36:39], v[72:75], v[136:139], v[36:39]
    v_mfma_f32_16x16x32_bf16 v[40:43], v[72:75], v[104:107], v[40:43]
    v_mfma_f32_16x16x32_bf16 v[40:43], v[72:75], v[140:143], v[40:43]
    v_mfma_f32_16x16x32_bf16 v[44:47], v[72:75], v[108:111], v[44:47]
    v_mfma_f32_16x16x32_bf16 v[44:47], v[72:75], v[144:147], v[44:47]
    v_mfma_f32_16x16x32_bf16 v[48:51], v[72:75], v[112:115], v[48:51]
    v_mfma_f32_16x16x32_bf16 v[48:51], v[72:75], v[148:151], v[48:51]
    v_mfma_f32_16x16x32_bf16 v[52:55], v[72:75], v[116:119], v[52:55]
    v_mfma_f32_16x16x32_bf16 v[52:55], v[72:75], v[152:155], v[52:55]
    v_mfma_f32_16x16x32_bf16 v[56:59], v[72:75], v[120:123], v[56:59]
    v_mfma_f32_16x16x32_bf16 v[56:59], v[72:75], v[156:159], v[56:59]
    v_mfma_f32_16x16x32_bf16 v[60:63], v[72:75], v[124:127], v[60:63]
    v_mfma_f32_16x16x32_bf16 v[60:63], v[72:75], v[160:163], v[60:63]
    s_waitcnt lgkmcnt(5)
    v_mfma_f32_16x16x32_bf16 v[40:43], v[76:79], v[100:103], v[40:43]
    v_mfma_f32_16x16x32_bf16 v[40:43], v[76:79], v[136:139], v[40:43]
    v_mfma_f32_16x16x32_bf16 v[44:47], v[76:79], v[104:107], v[44:47]
    v_mfma_f32_16x16x32_bf16 v[44:47], v[76:79], v[140:143], v[44:47]
    v_mfma_f32_16x16x32_bf16 v[48:51], v[76:79], v[108:111], v[48:51]
    v_mfma_f32_16x16x32_bf16 v[48:51], v[76:79], v[144:147], v[48:51]
    v_mfma_f32_16x16x32_bf16 v[52:55], v[76:79], v[112:115], v[52:55]
    v_mfma_f32_16x16x32_bf16 v[52:55], v[76:79], v[148:151], v[52:55]
    v_mfma_f32_16x16x32_bf16 v[56:59], v[76:79], v[116:119], v[56:59]
    v_mfma_f32_16x16x32_bf16 v[56:59], v[76:79], v[152:155], v[56:59]
    v_mfma_f32_16x16x32_bf16 v[60:63], v[76:79], v[120:123], v[60:63]
    v_mfma_f32_16x16x32_bf16 v[60:63], v[76:79], v[156:159], v[60:63]
    s_waitcnt lgkmcnt(4)
    v_mfma_f32_16x16x32_bf16 v[44:47], v[80:83], v[100:103], v[44:47]
    v_mfma_f32_16x16x32_bf16 v[44:47], v[80:83], v[136:139], v[44:47]
    v_mfma_f32_16x16x32_bf16 v[48:51], v[80:83], v[104:107], v[48:51]
    v_mfma_f32_16x16x32_bf16 v[48:51], v[80:83], v[140:143], v[48:51]
    v_mfma_f32_16x16x32_bf16 v[52:55], v[80:83], v[108:111], v[52:55]
    v_mfma_f32_16x16x32_bf16 v[52:55], v[80:83], v[144:147], v[52:55]
    v_mfma_f32_16x16x32_bf16 v[56:59], v[80:83], v[112:115], v[56:59]
    v_mfma_f32_16x16x32_bf16 v[56:59], v[80:83], v[148:151], v[56:59]
    v_mfma_f32_16x16x32_bf16 v[60:63], v[80:83], v[116:119], v[60:63]
    v_mfma_f32_16x16x32_bf16 v[60:63], v[80:83], v[152:155], v[60:63]
    s_waitcnt lgkmcnt(3)
    v_mfma_f32_16x16x32_bf16 v[48:51], v[84:87], v[100:103], v[48:51]
    v_mfma_f32_16x16x32_bf16 v[48:51], v[84:87], v[136:139], v[48:51]
    v_mfma_f32_16x16x32_bf16 v[52:55], v[84:87], v[104:107], v[52:55]
    v_mfma_f32_16x16x32_bf16 v[52:55], v[84:87], v[140:143], v[52:55]
    v_mfma_f32_16x16x32_bf16 v[56:59], v[84:87], v[108:111], v[56:59]
    v_mfma_f32_16x16x32_bf16 v[56:59], v[84:87], v[144:147], v[56:59]
    v_mfma_f32_16x16x32_bf16 v[60:63], v[84:87], v[112:115], v[60:63]
    v_mfma_f32_16x16x32_bf16 v[60:63], v[84:87], v[148:151], v[60:63]
    s_waitcnt lgkmcnt(2)
    v_mfma_f32_16x16x32_bf16 v[52:55], v[88:91], v[100:103], v[52:55]
    v_mfma_f32_16x16x32_bf16 v[52:55], v[88:91], v[136:139], v[52:55]
    v_mfma_f32_16x16x32_bf16 v[56:59], v[88:91], v[104:107], v[56:59]
    v_mfma_f32_16x16x32_bf16 v[56:59], v[88:91], v[140:143], v[56:59]
    v_mfma_f32_16x16x32_bf16 v[60:63], v[88:91], v[108:111], v[60:63]
    v_mfma_f32_16x16x32_bf16 v[60:63], v[88:91], v[144:147], v[60:63]
    s_waitcnt lgkmcnt(1)
    v_mfma_f32_16x16x32_bf16 v[56:59], v[92:95], v[100:103], v[56:59]
    v_mfma_f32_16x16x32_bf16 v[56:59], v[92:95], v[136:139], v[56:59]
    v_mfma_f32_16x16x32_bf16 v[60:63], v[92:95], v[104:107], v[60:63]
    v_mfma_f32_16x16x32_bf16 v[60:63], v[92:95], v[140:143], v[60:63]
    s_waitcnt lgkmcnt(0)
    v_mfma_f32_16x16x32_bf16 v[60:63], v[96:99], v[100:103], v[60:63]
    v_mfma_f32_16x16x32_bf16 v[60:63], v[96:99], v[136:139], v[60:63]
    s_branch K2_RED
K2_GEN:
    s_sub_u32 s4, s10, 1
    s_lshl_b32 s4, s4, 7
    v_subrev_u32 v13, s4, v13
    v_subrev_u32 v14, s4, v14
    ds_read_b128 v[100:103], v14 offset:4064
    ds_read_b128 v[136:139], v14 offset:9184
    ds_read_b128 v[104:107], v14 offset:3552
    ds_read_b128 v[140:143], v14 offset:8672
    ds_read_b128 v[108:111], v14 offset:3040
    ds_read_b128 v[144:147], v14 offset:8160
    ds_read_b128 v[112:115], v14 offset:2528
    ds_read_b128 v[148:151], v14 offset:7648
    ds_read_b128 v[116:119], v14 offset:2016
    ds_read_b128 v[152:155], v14 offset:7136
    ds_read_b128 v[120:123], v14 offset:1504
    ds_read_b128 v[156:159], v14 offset:6624
    ds_read_b128 v[124:127], v14 offset:992
    ds_read_b128 v[160:163], v14 offset:6112
    ds_read_b128 v[128:131], v14 offset:480
    ds_read_b128 v[164:167], v14 offset:5600
    ds_read_b128 v[68:71], v13 offset:448
    ds_read_b128 v[72:75], v13 offset:960
    ds_read_b128 v[76:79], v13 offset:1472
    ds_read_b128 v[80:83], v13 offset:1984
    ds_read_b128 v[84:87], v13 offset:2496
    ds_read_b128 v[88:91], v13 offset:3008
    ds_read_b128 v[92:95], v13 offset:3520
    ds_read_b128 v[96:99], v13 offset:4032
    s_waitcnt lgkmcnt(7)
    v_mfma_f32_16x16x32_bf16 v[32:35], v[68:71], v[100:103], v[32:35]
    v_mfma_f32_16x16x32_bf16 v[32:35], v[68:71], v[136:139], v[32:35]
    v_mfma_f32_16x16x32_bf16 v[36:39], v[68:71], v[104:107], v[36:39]
    v_mfma_f32_16x16x32_bf16 v[36:39], v[68:71], v[140:143], v[36:39]
    v_mfma_f32_16x16x32_bf16 v[40:43], v[68:71], v[108:111], v[40:43]
    v_mfma_f32_16x16x32_bf16 v[40:43], v[68:71], v[144:147], v[40:43]
    v_mfma_f32_16x16x32_bf16 v[44:47], v[68:71], v[112:115], v[44:47]
    v_mfma_f32_16x16x32_bf16 v[44:47], v[68:71], v[148:151], v[44:47]
    v_mfma_f32_16x16x32_bf16 v[48:51], v[68:71], v[116:119], v[48:51]
    v_mfma_f32_16x16x32_bf16 v[48:51], v[68:71], v[152:155], v[48:51]
    v_mfma_f32_16x16x32_bf16 v[52:55], v[68:71], v[120:123], v[52:55]
    v_mfma_f32_16x16x32_bf16 v[52:55], v[68:71], v[156:159], v[52:55]
    v_mfma_f32_16x16x32_bf16 v[56:59], v[68:71], v[124:127], v[56:59]
    v_mfma_f32_16x16x32_bf16 v[56:59], v[68:71], v[160:163], v[56:59]
    v_mfma_f32_16x16x32_bf16 v[60:63], v[68:71], v[128:131], v[60:63]
    v_mfma_f32_16x16x32_bf16 v[60:63], v[68:71], v[164:167], v[60:63]
    s_waitcnt lgkmcnt(6)
    v_mfma_f32_16x16x32_bf16 v[36:39], v[72:75], v[100:103], v[36:39]
    v_mfma_f32_16x16x32_bf16 v[36:39], v[72:75], v[136:139], v[36:39]
    v_mfma_f32_16x16x32_bf16 v[40:43], v[72:75], v[104:107], v[40:43]
    v_mfma_f32_16x16x32_bf16 v[40:43], v[72:75], v[140:143], v[40:43]
    v_mfma_f32_16x16x32_bf16 v[44:47], v[72:75], v[108:111], v[44:47]
    v_mfma_f32_16x16x32_bf16 v[44:47], v[72:75], v[144:147], v[44:47]
    v_mfma_f32_16x16x32_bf16 v[48:51], v[72:75], v[112:115], v[48:51]
    v_mfma_f32_16x16x32_bf16 v[48:51], v[72:75], v[148:151], v[48:51]
    v_mfma_f32_16x16x32_bf16 v[52:55], v[72:75], v[116:119], v[52:55]
    v_mfma_f32_16x16x32_bf16 v[52:55], v[72:75], v[152:155], v[52:55]
    v_mfma_f32_16x16x32_bf16 v[56:59], v[72:75], v[120:123], v[56:59]
    v_mfma_f32_16x16x32_bf16 v[56:59], v[72:75], v[156:159], v[56:59]
    v_mfma_f32_16x16x32_bf16 v[60:63], v[72:75], v[124:127], v[60:63]
    v_mfma_f32_16x16x32_bf16 v[60:63], v[72:75], v[160:163], v[60:63]
    s_waitcnt lgkmcnt(5)
    v_mfma_f32_16x16x32_bf16 v[40:43], v[76:79], v[100:103], v[40:43]
    v_mfma_f32_16x16x32_bf16 v[40:43], v[76:79], v[136:139], v[40:43]
    v_mfma_f32_16x16x32_bf16 v[44:47], v[76:79], v[104:107], v[44:47]
    v_mfma_f32_16x16x32_bf16 v[44:47], v[76:79], v[140:143], v[44:47]
    v_mfma_f32_16x16x32_bf16 v[48:51], v[76:79], v[108:111], v[48:51]
    v_mfma_f32_16x16x32_bf16 v[48:51], v[76:79], v[144:147], v[48:51]
    v_mfma_f32_16x16x32_bf16 v[52:55], v[76:79], v[112:115], v[52:55]
    v_mfma_f32_16x16x32_bf16 v[52:55], v[76:79], v[148:151], v[52:55]
    v_mfma_f32_16x16x32_bf16 v[56:59], v[76:79], v[116:119], v[56:59]
    v_mfma_f32_16x16x32_bf16 v[56:59], v[76:79], v[152:155], v[56:59]
    v_mfma_f32_16x16x32_bf16 v[60:63], v[76:79], v[120:123], v[60:63]
    v_mfma_f32_16x16x32_bf16 v[60:63], v[76:79], v[156:159], v[60:63]
    s_waitcnt lgkmcnt(4)
    v_mfma_f32_16x16x32_bf16 v[44:47], v[80:83], v[100:103], v[44:47]
    v_mfma_f32_16x16x32_bf16 v[44:47], v[80:83], v[136:139], v[44:47]
    v_mfma_f32_16x16x32_bf16 v[48:51], v[80:83], v[104:107], v[48:51]
    v_mfma_f32_16x16x32_bf16 v[48:51], v[80:83], v[140:143], v[48:51]
    v_mfma_f32_16x16x32_bf16 v[52:55], v[80:83], v[108:111], v[52:55]
    v_mfma_f32_16x16x32_bf16 v[52:55], v[80:83], v[144:147], v[52:55]
    v_mfma_f32_16x16x32_bf16 v[56:59], v[80:83], v[112:115], v[56:59]
    v_mfma_f32_16x16x32_bf16 v[56:59], v[80:83], v[148:151], v[56:59]
    v_mfma_f32_16x16x32_bf16 v[60:63], v[80:83], v[116:119], v[60:63]
    v_mfma_f32_16x16x32_bf16 v[60:63], v[80:83], v[152:155], v[60:63]
    s_waitcnt lgkmcnt(3)
    v_mfma_f32_16x16x32_bf16 v[48:51], v[84:87], v[100:103], v[48:51]
    v_mfma_f32_16x16x32_bf16 v[48:51], v[84:87], v[136:139], v[48:51]
    v_mfma_f32_16x16x32_bf16 v[52:55], v[84:87], v[104:107], v[52:55]
    v_mfma_f32_16x16x32_bf16 v[52:55], v[84:87], v[140:143], v[52:55]
    v_mfma_f32_16x16x32_bf16 v[56:59], v[84:87], v[108:111], v[56:59]
    v_mfma_f32_16x16x32_bf16 v[56:59], v[84:87], v[144:147], v[56:59]
    v_mfma_f32_16x16x32_bf16 v[60:63], v[84:87], v[112:115], v[60:63]
    v_mfma_f32_16x16x32_bf16 v[60:63], v[84:87], v[148:151], v[60:63]
    s_waitcnt lgkmcnt(2)
    v_mfma_f32_16x16x32_bf16 v[52:55], v[88:91], v[100:103], v[52:55]
    v_mfma_f32_16x16x32_bf16 v[52:55], v[88:91], v[136:139], v[52:55]
    v_mfma_f32_16x16x32_bf16 v[56:59], v[88:91], v[104:107], v[56:59]
    v_mfma_f32_16x16x32_bf16 v[56:59], v[88:91], v[140:143], v[56:59]
    v_mfma_f32_16x16x32_bf16 v[60:63], v[88:91], v[108:111], v[60:63]
    v_mfma_f32_16x16x32_bf16 v[60:63], v[88:91], v[144:147], v[60:63]
    s_waitcnt lgkmcnt(1)
    v_mfma_f32_16x16x32_bf16 v[56:59], v[92:95], v[100:103], v[56:59]
    v_mfma_f32_16x16x32_bf16 v[56:59], v[92:95], v[136:139], v[56:59]
    v_mfma_f32_16x16x32_bf16 v[60:63], v[92:95], v[104:107], v[60:63]
    v_mfma_f32_16x16x32_bf16 v[60:63], v[92:95], v[140:143], v[60:63]
    s_waitcnt lgkmcnt(0)
    v_mfma_f32_16x16x32_bf16 v[60:63], v[96:99], v[100:103], v[60:63]
    v_mfma_f32_16x16x32_bf16 v[60:63], v[96:99], v[136:139], v[60:63]
    ds_read_b128 v[100:103], v14 offset:4000
    ds_read_b128 v[136:139], v14 offset:9120
    ds_read_b128 v[104:107], v14 offset:3488
    ds_read_b128 v[140:143], v14 offset:8608
    ds_read_b128 v[108:111], v14 offset:2976
    ds_read_b128 v[144:147], v14 offset:8096
    ds_read_b128 v[112:115], v14 offset:2464
    ds_read_b128 v[148:151], v14 offset:7584
    ds_read_b128 v[116:119], v14 offset:1952
    ds_read_b128 v[152:155], v14 offset:7072
    ds_read_b128 v[120:123], v14 offset:1440
    ds_read_b128 v[156:159], v14 offset:6560
    ds_read_b128 v[124:127], v14 offset:928
    ds_read_b128 v[160:163], v14 offset:6048
    ds_read_b128 v[128:131], v14 offset:416
    ds_read_b128 v[164:167], v14 offset:5536
    ds_read_b128 v[68:71], v13 offset:384
    ds_read_b128 v[72:75], v13 offset:896
    ds_read_b128 v[76:79], v13 offset:1408
    ds_read_b128 v[80:83], v13 offset:1920
    ds_read_b128 v[84:87], v13 offset:2432
    ds_read_b128 v[88:91], v13 offset:2944
    ds_read_b128 v[92:95], v13 offset:3456
    ds_read_b128 v[96:99], v13 offset:3968
    s_waitcnt lgkmcnt(7)
    v_mfma_f32_16x16x32_bf16 v[32:35], v[68:71], v[100:103], v[32:35]
    v_mfma_f32_16x16x32_bf16 v[32:35], v[68:71], v[136:139], v[32:35]
    v_mfma_f32_16x16x32_bf16 v[36:39], v[68:71], v[104:107], v[36:39]
    v_mfma_f32_16x16x32_bf16 v[36:39], v[68:71], v[140:143], v[36:39]
    v_mfma_f32_16x16x32_bf16 v[40:43], v[68:71], v[108:111], v[40:43]
    v_mfma_f32_16x16x32_bf16 v[40:43], v[68:71], v[144:147], v[40:43]
    v_mfma_f32_16x16x32_bf16 v[44:47], v[68:71], v[112:115], v[44:47]
    v_mfma_f32_16x16x32_bf16 v[44:47], v[68:71], v[148:151], v[44:47]
    v_mfma_f32_16x16x32_bf16 v[48:51], v[68:71], v[116:119], v[48:51]
    v_mfma_f32_16x16x32_bf16 v[48:51], v[68:71], v[152:155], v[48:51]
    v_mfma_f32_16x16x32_bf16 v[52:55], v[68:71], v[120:123], v[52:55]
    v_mfma_f32_16x16x32_bf16 v[52:55], v[68:71], v[156:159], v[52:55]
    v_mfma_f32_16x16x32_bf16 v[56:59], v[68:71], v[124:127], v[56:59]
    v_mfma_f32_16x16x32_bf16 v[56:59], v[68:71], v[160:163], v[56:59]
    v_mfma_f32_16x16x32_bf16 v[60:63], v[68:71], v[128:131], v[60:63]
    v_mfma_f32_16x16x32_bf16 v[60:63], v[68:71], v[164:167], v[60:63]
    s_waitcnt lgkmcnt(6)
    v_mfma_f32_16x16x32_bf16 v[36:39], v[72:75], v[100:103], v[36:39]
    v_mfma_f32_16x16x32_bf16 v[36:39], v[72:75], v[136:139], v[36:39]
    v_mfma_f32_16x16x32_bf16 v[40:43], v[72:75], v[104:107], v[40:43]
    v_mfma_f32_16x16x32_bf16 v[40:43], v[72:75], v[140:143], v[40:43]
    v_mfma_f32_16x16x32_bf16 v[44:47], v[72:75], v[108:111], v[44:47]
    v_mfma_f32_16x16x32_bf16 v[44:47], v[72:75], v[144:147], v[44:47]
    v_mfma_f32_16x16x32_bf16 v[48:51], v[72:75], v[112:115], v[48:51]
    v_mfma_f32_16x16x32_bf16 v[48:51], v[72:75], v[148:151], v[48:51]
    v_mfma_f32_16x16x32_bf16 v[52:55], v[72:75], v[116:119], v[52:55]
    v_mfma_f32_16x16x32_bf16 v[52:55], v[72:75], v[152:155], v[52:55]
    v_mfma_f32_16x16x32_bf16 v[56:59], v[72:75], v[120:123], v[56:59]
    v_mfma_f32_16x16x32_bf16 v[56:59], v[72:75], v[156:159], v[56:59]
    v_mfma_f32_16x16x32_bf16 v[60:63], v[72:75], v[124:127], v[60:63]
    v_mfma_f32_16x16x32_bf16 v[60:63], v[72:75], v[160:163], v[60:63]
    s_waitcnt lgkmcnt(5)
    v_mfma_f32_16x16x32_bf16 v[40:43], v[76:79], v[100:103], v[40:43]
    v_mfma_f32_16x16x32_bf16 v[40:43], v[76:79], v[136:139], v[40:43]
    v_mfma_f32_16x16x32_bf16 v[44:47], v[76:79], v[104:107], v[44:47]
    v_mfma_f32_16x16x32_bf16 v[44:47], v[76:79], v[140:143], v[44:47]
    v_mfma_f32_16x16x32_bf16 v[48:51], v[76:79], v[108:111], v[48:51]
    v_mfma_f32_16x16x32_bf16 v[48:51], v[76:79], v[144:147], v[48:51]
    v_mfma_f32_16x16x32_bf16 v[52:55], v[76:79], v[112:115], v[52:55]
    v_mfma_f32_16x16x32_bf16 v[52:55], v[76:79], v[148:151], v[52:55]
    v_mfma_f32_16x16x32_bf16 v[56:59], v[76:79], v[116:119], v[56:59]
    v_mfma_f32_16x16x32_bf16 v[56:59], v[76:79], v[152:155], v[56:59]
    v_mfma_f32_16x16x32_bf16 v[60:63], v[76:79], v[120:123], v[60:63]
    v_mfma_f32_16x16x32_bf16 v[60:63], v[76:79], v[156:159], v[60:63]
    s_waitcnt lgkmcnt(4)
    v_mfma_f32_16x16x32_bf16 v[44:47], v[80:83], v[100:103], v[44:47]
    v_mfma_f32_16x16x32_bf16 v[44:47], v[80:83], v[136:139], v[44:47]
    v_mfma_f32_16x16x32_bf16 v[48:51], v[80:83], v[104:107], v[48:51]
    v_mfma_f32_16x16x32_bf16 v[48:51], v[80:83], v[140:143], v[48:51]
    v_mfma_f32_16x16x32_bf16 v[52:55], v[80:83], v[108:111], v[52:55]
    v_mfma_f32_16x16x32_bf16 v[52:55], v[80:83], v[144:147], v[52:55]
    v_mfma_f32_16x16x32_bf16 v[56:59], v[80:83], v[112:115], v[56:59]
    v_mfma_f32_16x16x32_bf16 v[56:59], v[80:83], v[148:151], v[56:59]
    v_mfma_f32_16x16x32_bf16 v[60:63], v[80:83], v[116:119], v[60:63]
    v_mfma_f32_16x16x32_bf16 v[60:63], v[80:83], v[152:155], v[60:63]
    s_waitcnt lgkmcnt(3)
    v_mfma_f32_16x16x32_bf16 v[48:51], v[84:87], v[100:103], v[48:51]
    v_mfma_f32_16x16x32_bf16 v[48:51], v[84:87], v[136:139], v[48:51]
    v_mfma_f32_16x16x32_bf16 v[52:55], v[84:87], v[104:107], v[52:55]
    v_mfma_f32_16x16x32_bf16 v[52:55], v[84:87], v[140:143], v[52:55]
    v_mfma_f32_16x16x32_bf16 v[56:59], v[84:87], v[108:111], v[56:59]
    v_mfma_f32_16x16x32_bf16 v[56:59], v[84:87], v[144:147], v[56:59]
    v_mfma_f32_16x16x32_bf16 v[60:63], v[84:87], v[112:115], v[60:63]
    v_mfma_f32_16x16x32_bf16 v[60:63], v[84:87], v[148:151], v[60:63]
    s_waitcnt lgkmcnt(2)
    v_mfma_f32_16x16x32_bf16 v[52:55], v[88:91], v[100:103], v[52:55]
    v_mfma_f32_16x16x32_bf16 v[52:55], v[88:91], v[136:139], v[52:55]
    v_mfma_f32_16x16x32_bf16 v[56:59], v[88:91], v[104:107], v[56:59]
    v_mfma_f32_16x16x32_bf16 v[56:59], v[88:91], v[140:143], v[56:59]
    v_mfma_f32_16x16x32_bf16 v[60:63], v[88:91], v[108:111], v[60:63]
    v_mfma_f32_16x16x32_bf16 v[60:63], v[88:91], v[144:147], v[60:63]
    s_waitcnt lgkmcnt(1)
    v_mfma_f32_16x16x32_bf16 v[56:59], v[92:95], v[100:103], v[56:59]
    v_mfma_f32_16x16x32_bf16 v[56:59], v[92:95], v[136:139], v[56:59]
    v_mfma_f32_16x16x32_bf16 v[60:63], v[92:95], v[104:107], v[60:63]
    v_mfma_f32_16x16x32_bf16 v[60:63], v[92:95], v[140:143], v[60:63]
    s_waitcnt lgkmcnt(0)
    v_mfma_f32_16x16x32_bf16 v[60:63], v[96:99], v[100:103], v[60:63]
    v_mfma_f32_16x16x32_bf16 v[60:63], v[96:99], v[136:139], v[60:63]
K2_RED:
    v_lshlrev_b32 v184, 16, v176
    v_and_b32 v185, s23, v176
    v_lshlrev_b32 v192, 16, v180
    v_and_b32 v193, s23, v180
    v_pk_add_f32 v[184:185], v[184:185], v[192:193]
    v_lshlrev_b32 v186, 16, v177
    v_and_b32 v187, s23, v177
    v_lshlrev_b32 v192, 16, v181
    v_and_b32 v193, s23, v181
    v_pk_add_f32 v[186:187], v[186:187], v[192:193]
    v_lshlrev_b32 v188, 16, v178
    v_and_b32 v189, s23, v178
    v_lshlrev_b32 v192, 16, v182
    v_and_b32 v193, s23, v182
    v_pk_add_f32 v[188:189], v[188:189], v[192:193]
    v_lshlrev_b32 v190, 16, v179
    v_and_b32 v191, s23, v179
    v_lshlrev_b32 v192, 16, v183
    v_and_b32 v193, s23, v183
    v_pk_add_f32 v[190:191], v[190:191], v[192:193]
    v_lshlrev_b32 v1, 5, v0
    ds_write_b128 v1, v[184:187]
    ds_write_b128 v1, v[188:191] offset:16
    s_lshl_b32 s4, s8, 13
    s_add_u32 s4, s4, 68224
    v_lshlrev_b32 v3, 4, v2
    v_add_u32 v4, s4, v3
    s_lshl_b32 s5, s9, 15
    s_lshl_b32 s6, s10, 11
    s_add_u32 s5, s5, s6
    s_add_u32 s5, s5, 68224
    v_add_u32 v5, s5, v3
    s_barrier
    ds_write_b128 v4, v[32:35] offset:0
    ds_write_b128 v4, v[36:39] offset:1024
    ds_write_b128 v4, v[40:43] offset:2048
    ds_write_b128 v4, v[44:47] offset:3072
    ds_write_b128 v4, v[48:51] offset:4096
    ds_write_b128 v4, v[52:55] offset:5120
    ds_write_b128 v4, v[56:59] offset:6144
    ds_write_b128 v4, v[60:63] offset:7168
    s_waitcnt lgkmcnt(0)
    s_barrier
    ds_read_b128 v[64:67], v5 offset:0
    ds_read_b128 v[68:71], v5 offset:1024
    ds_read_b128 v[72:75], v5 offset:8192
    ds_read_b128 v[76:79], v5 offset:9216
    ds_read_b128 v[80:83], v5 offset:16384
    ds_read_b128 v[84:87], v5 offset:17408
    ds_read_b128 v[88:91], v5 offset:24576
    ds_read_b128 v[92:95], v5 offset:25600
    s_lshl_b32 s6, s15, 16
    s_and_b32 s7, s15, 0xffff0000
    s_cmp_eq_u32 s9, 0
    s_cselect_b32 s6, s6, s7
    s_waitcnt lgkmcnt(0)
    v_add_f32 v64, v64, v72
    v_add_f32 v80, v80, v88
    v_add_f32 v65, v65, v73
    v_add_f32 v81, v81, v89
    v_add_f32 v66, v66, v74
    v_add_f32 v82, v82, v90
    v_add_f32 v67, v67, v75
    v_add_f32 v83, v83, v91
    v_add_f32 v68, v68, v76
    v_add_f32 v84, v84, v92
    v_add_f32 v69, v69, v77
    v_add_f32 v85, v85, v93
    v_add_f32 v70, v70, v78
    v_add_f32 v86, v86, v94
    v_add_f32 v71, v71, v79
    v_add_f32 v87, v87, v95
    v_add_f32 v64, v64, v80
    v_add_f32 v65, v65, v81
    v_add_f32 v66, v66, v82
    v_add_f32 v67, v67, v83
    v_add_f32 v68, v68, v84
    v_add_f32 v69, v69, v85
    v_add_f32 v70, v70, v86
    v_add_f32 v71, v71, v87
    v_cvt_pk_bf16_f32 v64, v64, v64
    v_lshlrev_b32 v64, 16, v64
    v_lshlrev_b32 v90, 16, v20
    v_lshlrev_b32 v91, 16, v16
    v_mul_f32 v90, s6, v90
    v_cvt_pk_bf16_f32 v90, v90, v90
    v_lshlrev_b32 v90, 16, v90
    v_add_f32 v64, v64, v90
    v_cvt_pk_bf16_f32 v64, v64, v64
    v_lshlrev_b32 v64, 16, v64
    v_add_f32 v64, v64, v91
    v_cvt_pk_bf16_f32 v65, v65, v65
    v_lshlrev_b32 v65, 16, v65
    v_and_b32 v92, 0xffff0000, v20
    v_and_b32 v93, 0xffff0000, v16
    v_mul_f32 v92, s6, v92
    v_cvt_pk_bf16_f32 v92, v92, v92
    v_lshlrev_b32 v92, 16, v92
    v_add_f32 v65, v65, v92
    v_cvt_pk_bf16_f32 v65, v65, v65
    v_lshlrev_b32 v65, 16, v65
    v_add_f32 v65, v65, v93
    v_cvt_pk_bf16_f32 v66, v66, v66
    v_lshlrev_b32 v66, 16, v66
    v_lshlrev_b32 v94, 16, v21
    v_lshlrev_b32 v95, 16, v17
    v_mul_f32 v94, s6, v94
    v_cvt_pk_bf16_f32 v94, v94, v94
    v_lshlrev_b32 v94, 16, v94
    v_add_f32 v66, v66, v94
    v_cvt_pk_bf16_f32 v66, v66, v66
    v_lshlrev_b32 v66, 16, v66
    v_add_f32 v66, v66, v95
    v_cvt_pk_bf16_f32 v67, v67, v67
    v_lshlrev_b32 v67, 16, v67
    v_and_b32 v96, 0xffff0000, v21
    v_and_b32 v97, 0xffff0000, v17
    v_mul_f32 v96, s6, v96
    v_cvt_pk_bf16_f32 v96, v96, v96
    v_lshlrev_b32 v96, 16, v96
    v_add_f32 v67, v67, v96
    v_cvt_pk_bf16_f32 v67, v67, v67
    v_lshlrev_b32 v67, 16, v67
    v_add_f32 v67, v67, v97
    v_cvt_pk_bf16_f32 v100, v64, v65
    v_cvt_pk_bf16_f32 v101, v66, v67
    global_store_dwordx2 v12, v[100:101], s[44:45] offset:0 sc1
    v_cvt_pk_bf16_f32 v68, v68, v68
    v_lshlrev_b32 v68, 16, v68
    v_lshlrev_b32 v90, 16, v22
    v_lshlrev_b32 v91, 16, v18
    v_mul_f32 v90, s6, v90
    v_cvt_pk_bf16_f32 v90, v90, v90
    v_lshlrev_b32 v90, 16, v90
    v_add_f32 v68, v68, v90
    v_cvt_pk_bf16_f32 v68, v68, v68
    v_lshlrev_b32 v68, 16, v68
    v_add_f32 v68, v68, v91
    v_cvt_pk_bf16_f32 v69, v69, v69
    v_lshlrev_b32 v69, 16, v69
    v_and_b32 v92, 0xffff0000, v22
    v_and_b32 v93, 0xffff0000, v18
    v_mul_f32 v92, s6, v92
    v_cvt_pk_bf16_f32 v92, v92, v92
    v_lshlrev_b32 v92, 16, v92
    v_add_f32 v69, v69, v92
    v_cvt_pk_bf16_f32 v69, v69, v69
    v_lshlrev_b32 v69, 16, v69
    v_add_f32 v69, v69, v93
    v_cvt_pk_bf16_f32 v70, v70, v70
    v_lshlrev_b32 v70, 16, v70
    v_lshlrev_b32 v94, 16, v23
    v_lshlrev_b32 v95, 16, v19
    v_mul_f32 v94, s6, v94
    v_cvt_pk_bf16_f32 v94, v94, v94
    v_lshlrev_b32 v94, 16, v94
    v_add_f32 v70, v70, v94
    v_cvt_pk_bf16_f32 v70, v70, v70
    v_lshlrev_b32 v70, 16, v70
    v_add_f32 v70, v70, v95
    v_cvt_pk_bf16_f32 v71, v71, v71
    v_lshlrev_b32 v71, 16, v71
    v_and_b32 v96, 0xffff0000, v23
    v_and_b32 v97, 0xffff0000, v19
    v_mul_f32 v96, s6, v96
    v_cvt_pk_bf16_f32 v96, v96, v96
    v_lshlrev_b32 v96, 16, v96
    v_add_f32 v71, v71, v96
    v_cvt_pk_bf16_f32 v71, v71, v71
    v_lshlrev_b32 v71, 16, v71
    v_add_f32 v71, v71, v97
    v_cvt_pk_bf16_f32 v102, v68, v69
    v_cvt_pk_bf16_f32 v103, v70, v71
    global_store_dwordx2 v12, v[102:103], s[44:45] offset:512 sc1
    s_cmp_ge_u32 s2, 144
    s_cbranch_scc1 K2_FIN
    s_cmp_ge_u32 s8, 2
    s_cbranch_scc1 K2_FIN
    v_lshlrev_b32 v1, 2, v0
    ds_read_b32 v104, v1 offset:0
    ds_read_b32 v105, v1 offset:512
    ds_read_b32 v106, v1 offset:1024
    ds_read_b32 v107, v1 offset:1536
    ds_read_b32 v108, v1 offset:2048
    ds_read_b32 v109, v1 offset:2560
    ds_read_b32 v110, v1 offset:3072
    ds_read_b32 v111, v1 offset:3584
    ds_read_b32 v112, v1 offset:4096
    ds_read_b32 v113, v1 offset:4608
    ds_read_b32 v114, v1 offset:5120
    ds_read_b32 v115, v1 offset:5632
    ds_read_b32 v116, v1 offset:6144
    ds_read_b32 v117, v1 offset:6656
    ds_read_b32 v118, v1 offset:7168
    ds_read_b32 v119, v1 offset:7680
    ds_read_b32 v120, v1 offset:8192
    ds_read_b32 v121, v1 offset:8704
    ds_read_b32 v122, v1 offset:9216
    ds_read_b32 v123, v1 offset:9728
    ds_read_b32 v124, v1 offset:10240
    ds_read_b32 v125, v1 offset:10752
    ds_read_b32 v126, v1 offset:11264
    ds_read_b32 v127, v1 offset:11776
    ds_read_b32 v128, v1 offset:12288
    ds_read_b32 v129, v1 offset:12800
    ds_read_b32 v130, v1 offset:13312
    ds_read_b32 v131, v1 offset:13824
    ds_read_b32 v132, v1 offset:14336
    ds_read_b32 v133, v1 offset:14848
    ds_read_b32 v134, v1 offset:15360
    ds_read_b32 v135, v1 offset:15872
    s_mul_hi_u32 s12, s2, 238609295
    s_mul_i32 s5, s12, 18
    s_sub_u32 s13, s2, s5
    s_cmp_lt_u32 s13, 4
    s_mov_b32 s6, 29360128
    s_mov_b32 s10, 2048
    s_cselect_b32 s5, 0, 4
    s_cselect_b32 s6, s6, 29376512
    s_cselect_b32 s10, s10, 7168
    s_sub_u32 s13, s13, s5
    s_lshl_b32 s7, s13, 9
    s_add_u32 s6, s6, s7
    s_mul_i32 s7, s12, s10
    s_add_u32 s6, s6, s7
    v_add_u32 v1, s6, v1
    s_waitcnt lgkmcnt(0)
    v_add_f32 v104, v104, v120
    v_add_f32 v105, v105, v121
    v_add_f32 v106, v106, v122
    v_add_f32 v107, v107, v123
    v_add_f32 v108, v108, v124
    v_add_f32 v109, v109, v125
    v_add_f32 v110, v110, v126
    v_add_f32 v111, v111, v127
    v_add_f32 v112, v112, v128
    v_add_f32 v113, v113, v129
    v_add_f32 v114, v114, v130
    v_add_f32 v115, v115, v131
    v_add_f32 v116, v116, v132
    v_add_f32 v117, v117, v133
    v_add_f32 v118, v118, v134
    v_add_f32 v119, v119, v135
    v_add_f32 v104, v104, v112
    v_add_f32 v105, v105, v113
    v_add_f32 v106, v106, v114
    v_add_f32 v107, v107, v115
    v_add_f32 v108, v108, v116
    v_add_f32 v109, v109, v117
    v_add_f32 v110, v110, v118
    v_add_f32 v111, v111, v119
    v_add_f32 v104, v104, v108
    v_add_f32 v105, v105, v109
    v_add_f32 v106, v106, v110
    v_add_f32 v107, v107, v111
    v_add_f32 v104, v104, v106
    v_add_f32 v105, v105, v107
    v_add_f32 v104, v104, v105
    global_store_dword v1, v104, s[32:33] sc1
K2_FIN:
K2_END:
    s_endpgm
.globl k3_kernel
.p2align 8
.type k3_kernel,@function
k3_kernel:
    s_cmp_ge_u32 s2, 256
    s_cbranch_scc1 K3_END
    s_load_dwordx8 s[64:71], s[0:1], 80
    s_load_dwordx4 s[72:75], s[0:1], 112
    s_load_dwordx2 s[32:33], s[0:1], 128
    v_lshrrev_b32 v1, 6, v0
    s_nop 0
    v_readfirstlane_b32 s8, v1
    v_and_b32 v2, 63, v0
    v_and_b32 v9, 15, v0
    v_bfe_u32 v10, v0, 4, 2
    s_waitcnt lgkmcnt(0)
    s_cmp_ge_u32 s8, 4
    s_cbranch_scc1 K3_C
    s_getpc_b64 s[76:77]
K3_PC:
    v_lshlrev_b32 v1, 4, v0
    global_load_dwordx4 v[120:123], v1, s[76:77]
    v_add_u32 v1, 0x1000, v1
    v_cmp_gt_u32 vcc, K3_CODE_END-K3_PC-16, v1
    s_and_saveexec_b64 s[78:79], vcc
    s_cbranch_execz K3_NOPF
    global_load_dwordx4 v[124:127], v1, s[76:77]
K3_NOPF:
    s_mov_b64 exec, -1
    s_mov_b32 s16, s64
    s_mov_b32 s17, s65
    s_and_b32 s4, s2, 7
    s_lshl_b32 s4, s4, 2
    s_lshr_b32 s5, s2, 6
    s_add_u32 s4, s4, s5
    s_bfe_u32 s5, s2, 0x30003
    v_lshrrev_b32 v3, 3, v2
    v_bfe_u32 v5, v2, 4, 1
    v_lshlrev_b32 v5, 1, v5
    s_and_b32 s3, s8, 1
    s_lshl_b32 s3, s3, 2
    v_or_b32 v5, s3, v5
    v_and_b32 v1, 7, v2
    v_xor_b32 v5, v1, v5
    v_mul_u32_u24 v3, 4224, v3
    v_lshl_add_u32 v3, v5, 4, v3
    v_lshrrev_b32 v4, 3, v2
    v_bfe_u32 v5, v2, 4, 1
    v_lshlrev_b32 v5, 1, v5
    s_and_b32 s3, s8, 1
    s_lshl_b32 s3, s3, 2
    v_or_b32 v5, s3, v5
    v_and_b32 v1, 7, v2
    v_xor_b32 v5, v1, v5
    v_mul_u32_u24 v4, 1024, v4
    v_lshl_add_u32 v4, v5, 4, v4
    s_lshl_b32 s6, s4, 7
    s_mul_i32 s3, s8, 33792
    s_add_u32 s6, s6, s3
    s_lshl_b32 s7, s5, 7
    s_lshl_b32 s3, s8, 13
    s_add_u32 s7, s7, s3
    s_lshl_b32 s15, s8, 10
    v_bfe_u32 v6, v2, 4, 1
    v_lshlrev_b32 v6, 11, v6
    v_lshl_add_u32 v6, v9, 4, v6
    s_lshl_b32 s13, s5, 8
    s_lshl_b32 s3, s8, 12
    s_add_u32 s13, s13, s3
    s_add_u32 s13, s13, 29360128
    s_waitcnt lgkmcnt(0)
    s_add_u32 s36, s32, 8388608
    s_addc_u32 s37, s33, 0
    s_mov_b32 s38, 2162688
    s_mov_b32 s39, 0x00020000
    s_add_u32 s40, s16, 0
    s_addc_u32 s41, s17, 0
    s_mov_b32 s42, 524288
    s_mov_b32 s43, 0x00020000
    s_add_u32 s44, s32, 0
    s_addc_u32 s45, s33, 0
    s_mov_b32 s46, 33554432
    s_mov_b32 s47, 0x00020000
    s_add_u32 m0, s15, 65536
    s_nop 0
    buffer_load_dwordx4 v3, s[36:39], s6 offen lds
    s_add_u32 m0, s15, 0
    s_nop 0
    buffer_load_dwordx4 v4, s[40:43], s7 offen lds
    s_add_u32 m0, s15, 69632
    s_add_u32 s3, s6, 135168
    buffer_load_dwordx4 v3, s[36:39], s3 offen lds
    s_add_u32 m0, s15, 4096
    s_add_u32 s3, s7, 32768
    buffer_load_dwordx4 v4, s[40:43], s3 offen lds
    s_add_u32 m0, s15, 73728
    s_add_u32 s3, s6, 270336
    buffer_load_dwordx4 v3, s[36:39], s3 offen lds
    s_add_u32 m0, s15, 8192
    s_add_u32 s3, s7, 65536
    buffer_load_dwordx4 v4, s[40:43], s3 offen lds
    s_add_u32 m0, s15, 77824
    s_add_u32 s3, s6, 405504
    buffer_load_dwordx4 v3, s[36:39], s3 offen lds
    s_add_u32 m0, s15, 12288
    s_add_u32 s3, s7, 98304
    buffer_load_dwordx4 v4, s[40:43], s3 offen lds
    s_add_u32 m0, s15, 81920
    s_add_u32 s3, s6, 540672
    buffer_load_dwordx4 v3, s[36:39], s3 offen lds
    s_add_u32 m0, s15, 16384
    s_add_u32 s3, s7, 131072
    buffer_load_dwordx4 v4, s[40:43], s3 offen lds
    s_add_u32 m0, s15, 86016
    s_add_u32 s3, s6, 675840
    buffer_load_dwordx4 v3, s[36:39], s3 offen lds
    s_add_u32 m0, s15, 20480
    s_add_u32 s3, s7, 163840
    buffer_load_dwordx4 v4, s[40:43], s3 offen lds
    s_add_u32 m0, s15, 90112
    s_add_u32 s3, s6, 811008
    buffer_load_dwordx4 v3, s[36:39], s3 offen lds
    s_add_u32 m0, s15, 24576
    s_add_u32 s3, s7, 196608
    buffer_load_dwordx4 v4, s[40:43], s3 offen lds
    s_add_u32 m0, s15, 94208
    s_add_u32 s3, s6, 946176
    buffer_load_dwordx4 v3, s[36:39], s3 offen lds
    s_add_u32 m0, s15, 28672
    s_add_u32 s3, s7, 229376
    buffer_load_dwordx4 v4, s[40:43], s3 offen lds
    s_add_u32 m0, s15, 131072
    s_nop 0
    buffer_load_dwordx4 v6, s[44:47], s13 offen lds
    s_waitcnt vmcnt(9)
    s_barrier
    s_add_u32 m0, s15, 98304
    s_add_u32 s3, s6, 1081344
    buffer_load_dwordx4 v3, s[36:39], s3 offen lds
    s_add_u32 m0, s15, 32768
    s_add_u32 s3, s7, 262144
    buffer_load_dwordx4 v4, s[40:43], s3 offen lds
    s_add_u32 m0, s15, 102400
    s_add_u32 s3, s6, 1216512
    buffer_load_dwordx4 v3, s[36:39], s3 offen lds
    s_add_u32 m0, s15, 36864
    s_add_u32 s3, s7, 294912
    buffer_load_dwordx4 v4, s[40:43], s3 offen lds
    s_add_u32 m0, s15, 106496
    s_add_u32 s3, s6, 1351680
    buffer_load_dwordx4 v3, s[36:39], s3 offen lds
    s_add_u32 m0, s15, 40960
    s_add_u32 s3, s7, 327680
    buffer_load_dwordx4 v4, s[40:43], s3 offen lds
    s_add_u32 m0, s15, 110592
    s_add_u32 s3, s6, 1486848
    buffer_load_dwordx4 v3, s[36:39], s3 offen lds
    s_add_u32 m0, s15, 45056
    s_add_u32 s3, s7, 360448
    buffer_load_dwordx4 v4, s[40:43], s3 offen lds
    s_waitcnt vmcnt(8)
    s_barrier
    s_add_u32 m0, s15, 114688
    s_add_u32 s3, s6, 1622016
    buffer_load_dwordx4 v3, s[36:39], s3 offen lds
    s_add_u32 m0, s15, 49152
    s_add_u32 s3, s7, 393216
    buffer_load_dwordx4 v4, s[40:43], s3 offen lds
    s_add_u32 m0, s15, 118784
    s_add_u32 s3, s6, 1757184
    buffer_load_dwordx4 v3, s[36:39], s3 offen lds
    s_add_u32 m0, s15, 53248
    s_add_u32 s3, s7, 425984
    buffer_load_dwordx4 v4, s[40:43], s3 offen lds
    s_add_u32 m0, s15, 122880
    s_add_u32 s3, s6, 1892352
    buffer_load_dwordx4 v3, s[36:39], s3 offen lds
    s_add_u32 m0, s15, 57344
    s_add_u32 s3, s7, 458752
    buffer_load_dwordx4 v4, s[40:43], s3 offen lds
    s_add_u32 m0, s15, 126976
    s_add_u32 s3, s6, 2027520
    buffer_load_dwordx4 v3, s[36:39], s3 offen lds
    s_add_u32 m0, s15, 61440
    s_add_u32 s3, s7, 491520
    buffer_load_dwordx4 v4, s[40:43], s3 offen lds
    s_waitcnt vmcnt(8)
    s_barrier
    s_waitcnt vmcnt(0)
    s_barrier
    s_endpgm
K3_C:
    s_sub_u32 s8, s8, 4
    s_and_b32 s4, s2, 7
    s_lshl_b32 s4, s4, 2
    s_lshr_b32 s5, s2, 6
    s_add_u32 s4, s4, s5
    s_bfe_u32 s5, s2, 0x30003
    s_mov_b32 s20, 0x3f803f80
    s_mov_b32 s21, 0x3b000000
    s_mov_b32 s22, 0x3727c5ac
    s_mov_b32 s23, 0xffff0000
    s_mov_b32 s24, 0xc0135761
    s_mov_b32 s25, 0xbdd2d3e8
    s_bfe_u32 s9, s8, 0x10001
    s_and_b32 s10, s8, 1
    s_lshr_b32 s11, s8, 2
    s_lshl_b32 s12, s9, 2
    s_add_u32 s13, s12, 2
    s_lshl_b32 s14, s10, 2
    s_add_u32 s15, s14, 2
    s_lshl_b32 s28, s11, 12
    v_bfe_u32 v5, v9, 3, 1
    v_lshlrev_b32 v5, 1, v5
    v_and_b32 v6, 1, v10
    v_lshl_or_b32 v5, v6, 2, v5
    v_bfe_u32 v6, v9, 1, 1
    v_add_u32 v6, s12, v6
    v_xor_b32 v5, v5, v6
    v_lshlrev_b32 v5, 4, v5
    v_and_b32 v6, 1, v9
    v_lshl_add_u32 v5, v6, 3, v5
    v_lshrrev_b32 v6, 2, v9
    v_lshl_add_u32 v6, v10, 3, v6
    v_lshl_add_u32 v11, v6, 7, v5
    v_add_u32 v11, 65536, v11
    v_bfe_u32 v5, v9, 3, 1
    v_lshlrev_b32 v5, 1, v5
    v_and_b32 v6, 1, v10
    v_lshl_or_b32 v5, v6, 2, v5
    v_bfe_u32 v6, v9, 1, 1
    v_add_u32 v6, s13, v6
    v_xor_b32 v5, v5, v6
    v_lshlrev_b32 v5, 4, v5
    v_and_b32 v6, 1, v9
    v_lshl_add_u32 v5, v6, 3, v5
    v_lshrrev_b32 v6, 2, v9
    v_lshl_add_u32 v6, v10, 3, v6
    v_lshl_add_u32 v12, v6, 7, v5
    v_add_u32 v12, 65536, v12
    v_bfe_u32 v5, v9, 3, 1
    v_lshlrev_b32 v5, 1, v5
    v_and_b32 v6, 1, v10
    v_lshl_or_b32 v5, v6, 2, v5
    v_bfe_u32 v6, v9, 1, 1
    v_add_u32 v6, s14, v6
    v_xor_b32 v5, v5, v6
    v_lshlrev_b32 v5, 4, v5
    v_and_b32 v6, 1, v9
    v_lshl_add_u32 v5, v6, 3, v5
    v_lshrrev_b32 v6, 2, v9
    v_lshl_add_u32 v6, v10, 3, v6
    v_lshl_add_u32 v13, v6, 7, v5
    v_add_u32 v13, 0, v13
    v_bfe_u32 v5, v9, 3, 1
    v_lshlrev_b32 v5, 1, v5
    v_and_b32 v6, 1, v10
    v_lshl_or_b32 v5, v6, 2, v5
    v_bfe_u32 v6, v9, 1, 1
    v_add_u32 v6, s15, v6
    v_xor_b32 v5, v5, v6
    v_lshlrev_b32 v5, 4, v5
    v_and_b32 v6, 1, v9
    v_lshl_add_u32 v5, v6, 3, v5
    v_lshrrev_b32 v6, 2, v9
    v_lshl_add_u32 v6, v10, 3, v6
    v_lshl_add_u32 v14, v6, 7, v5
    v_add_u32 v14, 0, v14
    s_cmp_eq_u32 s11, 0
    s_cselect_b64 vcc, -1, 0
    v_cndmask_b32 v15, v12, v11, vcc
    s_lshl_b32 s3, s5, 1
    s_add_u32 s3, s3, s10
    s_lshl_b32 s29, s3, 12
    v_add_u32 v15, s29, v15
    v_add_u32 v11, s28, v11
    v_add_u32 v12, s28, v12
    v_add_u32 v13, s28, v13
    v_add_u32 v14, s28, v14
    s_mov_b32 s26, s25
    s_mov_b32 s27, s25
    v_mov_b32 v30, s24
    v_mov_b32 v31, s24
    v_mov_b32 v80, 0
    v_mov_b32 v81, 0
    v_mov_b32 v82, 0
    v_mov_b32 v83, 0
    v_mov_b32 v84, 0
    v_mov_b32 v85, 0
    v_mov_b32 v86, 0
    v_mov_b32 v87, 0
    v_mov_b32 v88, 0
    v_mov_b32 v89, 0
    v_mov_b32 v90, 0
    v_mov_b32 v91, 0
    v_mov_b32 v92, 0
    v_mov_b32 v93, 0
    v_mov_b32 v94, 0
    v_mov_b32 v95, 0
    v_mov_b32 v16, 0
    v_mov_b32 v17, 0
    v_mov_b32 v18, 0
    v_mov_b32 v19, 0
    v_mov_b32 v20, 0
    v_mov_b32 v21, 0
    v_mov_b32 v22, 0
    v_mov_b32 v23, 0
    v_mov_b32 v24, s20
    v_mov_b32 v25, s20
    v_mov_b32 v26, s20
    v_mov_b32 v27, s20
    s_cmp_eq_u32 s10, 1
    s_cbranch_scc1 K3_C1
    s_barrier
    ds_read_b64_tr_b16 v[32:33], v11 offset:0
    ds_read_b64_tr_b16 v[34:35], v11 offset:512
    ds_read_b64_tr_b16 v[36:37], v12 offset:0
    ds_read_b64_tr_b16 v[38:39], v12 offset:512
    ds_read_b64_tr_b16 v[56:57], v13 offset:0
    ds_read_b64_tr_b16 v[58:59], v13 offset:512
    ds_read_b64_tr_b16 v[60:61], v14 offset:0
    ds_read_b64_tr_b16 v[62:63], v14 offset:512
    ds_read_b64_tr_b16 v[40:41], v11 offset:8192
    ds_read_b64_tr_b16 v[42:43], v11 offset:8704
    ds_read_b64_tr_b16 v[44:45], v12 offset:8192
    ds_read_b64_tr_b16 v[46:47], v12 offset:8704
    ds_read_b64_tr_b16 v[64:65], v13 offset:8192
    ds_read_b64_tr_b16 v[66:67], v13 offset:8704
    ds_read_b64_tr_b16 v[68:69], v14 offset:8192
    ds_read_b64_tr_b16 v[70:71], v14 offset:8704
    s_waitcnt lgkmcnt(8)
    v_mfma_f32_16x16x32_bf16 v[16:19], v[24:27], v[32:35], v[16:19]
    v_mfma_f32_16x16x32_bf16 v[80:83], v[56:59], v[32:35], v[80:83]
    v_mfma_f32_16x16x32_bf16 v[84:87], v[60:63], v[32:35], v[84:87]
    v_mfma_f32_16x16x32_bf16 v[20:23], v[24:27], v[36:39], v[20:23]
    v_mfma_f32_16x16x32_bf16 v[88:91], v[56:59], v[36:39], v[88:91]
    v_mfma_f32_16x16x32_bf16 v[92:95], v[60:63], v[36:39], v[92:95]
    s_barrier
    ds_read_b64_tr_b16 v[48:49], v11 offset:16384
    ds_read_b64_tr_b16 v[50:51], v11 offset:16896
    ds_read_b64_tr_b16 v[52:53], v12 offset:16384
    ds_read_b64_tr_b16 v[54:55], v12 offset:16896
    ds_read_b64_tr_b16 v[72:73], v13 offset:16384
    ds_read_b64_tr_b16 v[74:75], v13 offset:16896
    ds_read_b64_tr_b16 v[76:77], v14 offset:16384
    ds_read_b64_tr_b16 v[78:79], v14 offset:16896
    s_waitcnt lgkmcnt(8)
    v_mfma_f32_16x16x32_bf16 v[16:19], v[24:27], v[40:43], v[16:19]
    v_mfma_f32_16x16x32_bf16 v[80:83], v[64:67], v[40:43], v[80:83]
    v_mfma_f32_16x16x32_bf16 v[84:87], v[68:71], v[40:43], v[84:87]
    v_mfma_f32_16x16x32_bf16 v[20:23], v[24:27], v[44:47], v[20:23]
    v_mfma_f32_16x16x32_bf16 v[88:91], v[64:67], v[44:47], v[88:91]
    v_mfma_f32_16x16x32_bf16 v[92:95], v[68:71], v[44:47], v[92:95]
    ds_read_b64_tr_b16 v[32:33], v11 offset:24576
    ds_read_b64_tr_b16 v[34:35], v11 offset:25088
    ds_read_b64_tr_b16 v[36:37], v12 offset:24576
    ds_read_b64_tr_b16 v[38:39], v12 offset:25088
    ds_read_b64_tr_b16 v[56:57], v13 offset:24576
    ds_read_b64_tr_b16 v[58:59], v13 offset:25088
    ds_read_b64_tr_b16 v[60:61], v14 offset:24576
    ds_read_b64_tr_b16 v[62:63], v14 offset:25088
    s_waitcnt lgkmcnt(8)
    v_mfma_f32_16x16x32_bf16 v[16:19], v[24:27], v[48:51], v[16:19]
    v_mfma_f32_16x16x32_bf16 v[80:83], v[72:75], v[48:51], v[80:83]
    v_mfma_f32_16x16x32_bf16 v[84:87], v[76:79], v[48:51], v[84:87]
    v_mfma_f32_16x16x32_bf16 v[20:23], v[24:27], v[52:55], v[20:23]
    v_mfma_f32_16x16x32_bf16 v[88:91], v[72:75], v[52:55], v[88:91]
    v_mfma_f32_16x16x32_bf16 v[92:95], v[76:79], v[52:55], v[92:95]
    s_barrier
    ds_read_b64_tr_b16 v[40:41], v11 offset:32768
    ds_read_b64_tr_b16 v[42:43], v11 offset:33280
    ds_read_b64_tr_b16 v[44:45], v12 offset:32768
    ds_read_b64_tr_b16 v[46:47], v12 offset:33280
    ds_read_b64_tr_b16 v[64:65], v13 offset:32768
    ds_read_b64_tr_b16 v[66:67], v13 offset:33280
    ds_read_b64_tr_b16 v[68:69], v14 offset:32768
    ds_read_b64_tr_b16 v[70:71], v14 offset:33280
    s_waitcnt lgkmcnt(8)
    v_mfma_f32_16x16x32_bf16 v[16:19], v[24:27], v[32:35], v[16:19]
    v_mfma_f32_16x16x32_bf16 v[80:83], v[56:59], v[32:35], v[80:83]
    v_mfma_f32_16x16x32_bf16 v[84:87], v[60:63], v[32:35], v[84:87]
    v_mfma_f32_16x16x32_bf16 v[20:23], v[24:27], v[36:39], v[20:23]
    v_mfma_f32_16x16x32_bf16 v[88:91], v[56:59], v[36:39], v[88:91]
    v_mfma_f32_16x16x32_bf16 v[92:95], v[60:63], v[36:39], v[92:95]
    ds_read_b64_tr_b16 v[48:49], v11 offset:40960
    ds_read_b64_tr_b16 v[50:51], v11 offset:41472
    ds_read_b64_tr_b16 v[52:53], v12 offset:40960
    ds_read_b64_tr_b16 v[54:55], v12 offset:41472
    ds_read_b64_tr_b16 v[72:73], v13 offset:40960
    ds_read_b64_tr_b16 v[74:75], v13 offset:41472
    ds_read_b64_tr_b16 v[76:77], v14 offset:40960
    ds_read_b64_tr_b16 v[78:79], v14 offset:41472
    s_waitcnt lgkmcnt(8)
    v_mfma_f32_16x16x32_bf16 v[16:19], v[24:27], v[40:43], v[16:19]
    v_mfma_f32_16x16x32_bf16 v[80:83], v[64:67], v[40:43], v[80:83]
    v_mfma_f32_16x16x32_bf16 v[84:87], v[68:71], v[40:43], v[84:87]
    v_mfma_f32_16x16x32_bf16 v[20:23], v[24:27], v[44:47], v[20:23]
    v_mfma_f32_16x16x32_bf16 v[88:91], v[64:67], v[44:47], v[88:91]
    v_mfma_f32_16x16x32_bf16 v[92:95], v[68:71], v[44:47], v[92:95]
    s_barrier
    ds_read_b64_tr_b16 v[32:33], v11 offset:49152
    ds_read_b64_tr_b16 v[34:35], v11 offset:49664
    ds_read_b64_tr_b16 v[36:37], v12 offset:49152
    ds_read_b64_tr_b16 v[38:39], v12 offset:49664
    ds_read_b64_tr_b16 v[56:57], v13 offset:49152
    ds_read_b64_tr_b16 v[58:59], v13 offset:49664
    ds_read_b64_tr_b16 v[60:61], v14 offset:49152
    ds_read_b64_tr_b16 v[62:63], v14 offset:49664
    s_waitcnt lgkmcnt(8)
    v_mfma_f32_16x16x32_bf16 v[16:19], v[24:27], v[48:51], v[16:19]
    v_mfma_f32_16x16x32_bf16 v[80:83], v[72:75], v[48:51], v[80:83]
    v_mfma_f32_16x16x32_bf16 v[84:87], v[76:79], v[48:51], v[84:87]
    v_mfma_f32_16x16x32_bf16 v[20:23], v[24:27], v[52:55], v[20:23]
    v_mfma_f32_16x16x32_bf16 v[88:91], v[72:75], v[52:55], v[88:91]
    v_mfma_f32_16x16x32_bf16 v[92:95], v[76:79], v[52:55], v[92:95]
    ds_read_b64_tr_b16 v[40:41], v11 offset:57344
    ds_read_b64_tr_b16 v[42:43], v11 offset:57856
    ds_read_b64_tr_b16 v[44:45], v12 offset:57344
    ds_read_b64_tr_b16 v[46:47], v12 offset:57856
    ds_read_b64_tr_b16 v[64:65], v13 offset:57344
    ds_read_b64_tr_b16 v[66:67], v13 offset:57856
    ds_read_b64_tr_b16 v[68:69], v14 offset:57344
    ds_read_b64_tr_b16 v[70:71], v14 offset:57856
    s_waitcnt lgkmcnt(8)
    v_mfma_f32_16x16x32_bf16 v[16:19], v[24:27], v[32:35], v[16:19]
    v_mfma_f32_16x16x32_bf16 v[80:83], v[56:59], v[32:35], v[80:83]
    v_mfma_f32_16x16x32_bf16 v[84:87], v[60:63], v[32:35], v[84:87]
    v_mfma_f32_16x16x32_bf16 v[20:23], v[24:27], v[36:39], v[20:23]
    v_mfma_f32_16x16x32_bf16 v[88:91], v[56:59], v[36:39], v[88:91]
    v_mfma_f32_16x16x32_bf16 v[92:95], v[60:63], v[36:39], v[92:95]
    s_waitcnt lgkmcnt(0)
    v_mfma_f32_16x16x32_bf16 v[16:19], v[24:27], v[40:43], v[16:19]
    v_mfma_f32_16x16x32_bf16 v[80:83], v[64:67], v[40:43], v[80:83]
    v_mfma_f32_16x16x32_bf16 v[84:87], v[68:71], v[40:43], v[84:87]
    v_mfma_f32_16x16x32_bf16 v[20:23], v[24:27], v[44:47], v[20:23]
    v_mfma_f32_16x16x32_bf16 v[88:91], v[64:67], v[44:47], v[88:91]
    v_mfma_f32_16x16x32_bf16 v[92:95], v[68:71], v[44:47], v[92:95]
    s_nop 7
    v_mov_b32 v96, v16
    v_mov_b32 v97, v20
    s_branch K3_C2
K3_C1:
    s_barrier
    ds_read_b64_tr_b16 v[32:33], v11 offset:0
    ds_read_b64_tr_b16 v[34:35], v11 offset:512
    ds_read_b64_tr_b16 v[36:37], v12 offset:0
    ds_read_b64_tr_b16 v[38:39], v12 offset:512
    ds_read_b64_tr_b16 v[56:57], v13 offset:0
    ds_read_b64_tr_b16 v[58:59], v13 offset:512
    ds_read_b64_tr_b16 v[60:61], v14 offset:0
    ds_read_b64_tr_b16 v[62:63], v14 offset:512
    ds_read_b64_tr_b16 v[40:41], v11 offset:8192
    ds_read_b64_tr_b16 v[42:43], v11 offset:8704
    ds_read_b64_tr_b16 v[44:45], v12 offset:8192
    ds_read_b64_tr_b16 v[46:47], v12 offset:8704
    ds_read_b64_tr_b16 v[64:65], v13 offset:8192
    ds_read_b64_tr_b16 v[66:67], v13 offset:8704
    ds_read_b64_tr_b16 v[68:69], v14 offset:8192
    ds_read_b64_tr_b16 v[70:71], v14 offset:8704
    s_waitcnt lgkmcnt(8)
    v_mfma_f32_16x16x32_bf16 v[16:19], v[32:35], v[32:35], v[16:19]
    v_mfma_f32_16x16x32_bf16 v[80:83], v[56:59], v[32:35], v[80:83]
    v_mfma_f32_16x16x32_bf16 v[84:87], v[60:63], v[32:35], v[84:87]
    v_mfma_f32_16x16x32_bf16 v[20:23], v[36:39], v[36:39], v[20:23]
    v_mfma_f32_16x16x32_bf16 v[88:91], v[56:59], v[36:39], v[88:91]
    v_mfma_f32_16x16x32_bf16 v[92:95], v[60:63], v[36:39], v[92:95]
    s_barrier
    ds_read_b64_tr_b16 v[48:49], v11 offset:16384
    ds_read_b64_tr_b16 v[50:51], v11 offset:16896
    ds_read_b64_tr_b16 v[52:53], v12 offset:16384
    ds_read_b64_tr_b16 v[54:55], v12 offset:16896
    ds_read_b64_tr_b16 v[72:73], v13 offset:16384
    ds_read_b64_tr_b16 v[74:75], v13 offset:16896
    ds_read_b64_tr_b16 v[76:77], v14 offset:16384
    ds_read_b64_tr_b16 v[78:79], v14 offset:16896
    s_waitcnt lgkmcnt(8)
    v_mfma_f32_16x16x32_bf16 v[16:19], v[40:43], v[40:43], v[16:19]
    v_mfma_f32_16x16x32_bf16 v[80:83], v[64:67], v[40:43], v[80:83]
    v_mfma_f32_16x16x32_bf16 v[84:87], v[68:71], v[40:43], v[84:87]
    v_mfma_f32_16x16x32_bf16 v[20:23], v[44:47], v[44:47], v[20:23]
    v_mfma_f32_16x16x32_bf16 v[88:91], v[64:67], v[44:47], v[88:91]
    v_mfma_f32_16x16x32_bf16 v[92:95], v[68:71], v[44:47], v[92:95]
    ds_read_b64_tr_b16 v[32:33], v11 offset:24576
    ds_read_b64_tr_b16 v[34:35], v11 offset:25088
    ds_read_b64_tr_b16 v[36:37], v12 offset:24576
    ds_read_b64_tr_b16 v[38:39], v12 offset:25088
    ds_read_b64_tr_b16 v[56:57], v13 offset:24576
    ds_read_b64_tr_b16 v[58:59], v13 offset:25088
    ds_read_b64_tr_b16 v[60:61], v14 offset:24576
    ds_read_b64_tr_b16 v[62:63], v14 offset:25088
    s_waitcnt lgkmcnt(8)
    v_mfma_f32_16x16x32_bf16 v[16:19], v[48:51], v[48:51], v[16:19]
    v_mfma_f32_16x16x32_bf16 v[80:83], v[72:75], v[48:51], v[80:83]
    v_mfma_f32_16x16x32_bf16 v[84:87], v[76:79], v[48:51], v[84:87]
    v_mfma_f32_16x16x32_bf16 v[20:23], v[52:55], v[52:55], v[20:23]
    v_mfma_f32_16x16x32_bf16 v[88:91], v[72:75], v[52:55], v[88:91]
    v_mfma_f32_16x16x32_bf16 v[92:95], v[76:79], v[52:55], v[92:95]
    s_barrier
    ds_read_b64_tr_b16 v[40:41], v11 offset:32768
    ds_read_b64_tr_b16 v[42:43], v11 offset:33280
    ds_read_b64_tr_b16 v[44:45], v12 offset:32768
    ds_read_b64_tr_b16 v[46:47], v12 offset:33280
    ds_read_b64_tr_b16 v[64:65], v13 offset:32768
    ds_read_b64_tr_b16 v[66:67], v13 offset:33280
    ds_read_b64_tr_b16 v[68:69], v14 offset:32768
    ds_read_b64_tr_b16 v[70:71], v14 offset:33280
    s_waitcnt lgkmcnt(8)
    v_mfma_f32_16x16x32_bf16 v[16:19], v[32:35], v[32:35], v[16:19]
    v_mfma_f32_16x16x32_bf16 v[80:83], v[56:59], v[32:35], v[80:83]
    v_mfma_f32_16x16x32_bf16 v[84:87], v[60:63], v[32:35], v[84:87]
    v_mfma_f32_16x16x32_bf16 v[20:23], v[36:39], v[36:39], v[20:23]
    v_mfma_f32_16x16x32_bf16 v[88:91], v[56:59], v[36:39], v[88:91]
    v_mfma_f32_16x16x32_bf16 v[92:95], v[60:63], v[36:39], v[92:95]
    ds_read_b64_tr_b16 v[48:49], v11 offset:40960
    ds_read_b64_tr_b16 v[50:51], v11 offset:41472
    ds_read_b64_tr_b16 v[52:53], v12 offset:40960
    ds_read_b64_tr_b16 v[54:55], v12 offset:41472
    ds_read_b64_tr_b16 v[72:73], v13 offset:40960
    ds_read_b64_tr_b16 v[74:75], v13 offset:41472
    ds_read_b64_tr_b16 v[76:77], v14 offset:40960
    ds_read_b64_tr_b16 v[78:79], v14 offset:41472
    s_waitcnt lgkmcnt(8)
    v_mfma_f32_16x16x32_bf16 v[16:19], v[40:43], v[40:43], v[16:19]
    v_mfma_f32_16x16x32_bf16 v[80:83], v[64:67], v[40:43], v[80:83]
    v_mfma_f32_16x16x32_bf16 v[84:87], v[68:71], v[40:43], v[84:87]
    v_mfma_f32_16x16x32_bf16 v[20:23], v[44:47], v[44:47], v[20:23]
    v_mfma_f32_16x16x32_bf16 v[88:91], v[64:67], v[44:47], v[88:91]
    v_mfma_f32_16x16x32_bf16 v[92:95], v[68:71], v[44:47], v[92:95]
    s_barrier
    ds_read_b64_tr_b16 v[32:33], v11 offset:49152
    ds_read_b64_tr_b16 v[34:35], v11 offset:49664
    ds_read_b64_tr_b16 v[36:37], v12 offset:49152
    ds_read_b64_tr_b16 v[38:39], v12 offset:49664
    ds_read_b64_tr_b16 v[56:57], v13 offset:49152
    ds_read_b64_tr_b16 v[58:59], v13 offset:49664
    ds_read_b64_tr_b16 v[60:61], v14 offset:49152
    ds_read_b64_tr_b16 v[62:63], v14 offset:49664
    s_waitcnt lgkmcnt(8)
    v_mfma_f32_16x16x32_bf16 v[16:19], v[48:51], v[48:51], v[16:19]
    v_mfma_f32_16x16x32_bf16 v[80:83], v[72:75], v[48:51], v[80:83]
    v_mfma_f32_16x16x32_bf16 v[84:87], v[76:79], v[48:51], v[84:87]
    v_mfma_f32_16x16x32_bf16 v[20:23], v[52:55], v[52:55], v[20:23]
    v_mfma_f32_16x16x32_bf16 v[88:91], v[72:75], v[52:55], v[88:91]
    v_mfma_f32_16x16x32_bf16 v[92:95], v[76:79], v[52:55], v[92:95]
    ds_read_b64_tr_b16 v[40:41], v11 offset:57344
    ds_read_b64_tr_b16 v[42:43], v11 offset:57856
    ds_read_b64_tr_b16 v[44:45], v12 offset:57344
    ds_read_b64_tr_b16 v[46:47], v12 offset:57856
    ds_read_b64_tr_b16 v[64:65], v13 offset:57344
    ds_read_b64_tr_b16 v[66:67], v13 offset:57856
    ds_read_b64_tr_b16 v[68:69], v14 offset:57344
    ds_read_b64_tr_b16 v[70:71], v14 offset:57856
    s_waitcnt lgkmcnt(8)
    v_mfma_f32_16x16x32_bf16 v[16:19], v[32:35], v[32:35], v[16:19]
    v_mfma_f32_16x16x32_bf16 v[80:83], v[56:59], v[32:35], v[80:83]
    v_mfma_f32_16x16x32_bf16 v[84:87], v[60:63], v[32:35], v[84:87]
    v_mfma_f32_16x16x32_bf16 v[20:23], v[36:39], v[36:39], v[20:23]
    v_mfma_f32_16x16x32_bf16 v[88:91], v[56:59], v[36:39], v[88:91]
    v_mfma_f32_16x16x32_bf16 v[92:95], v[60:63], v[36:39], v[92:95]
    s_waitcnt lgkmcnt(0)
    v_mfma_f32_16x16x32_bf16 v[16:19], v[40:43], v[40:43], v[16:19]
    v_mfma_f32_16x16x32_bf16 v[80:83], v[64:67], v[40:43], v[80:83]
    v_mfma_f32_16x16x32_bf16 v[84:87], v[68:71], v[40:43], v[84:87]
    v_mfma_f32_16x16x32_bf16 v[20:23], v[44:47], v[44:47], v[20:23]
    v_mfma_f32_16x16x32_bf16 v[88:91], v[64:67], v[44:47], v[88:91]
    v_mfma_f32_16x16x32_bf16 v[92:95], v[68:71], v[44:47], v[92:95]
    s_nop 7
    v_and_b32 v1, 3, v9
    v_lshrrev_b32 v3, 2, v9
    v_cmp_eq_u32 s[52:53], v3, v10
    v_mov_b32 v96, v16
    v_cmp_eq_u32 vcc, 1, v1
    s_nop 1
    v_cndmask_b32 v96, v96, v17, vcc
    v_cmp_eq_u32 vcc, 2, v1
    s_nop 1
    v_cndmask_b32 v96, v96, v18, vcc
    v_cmp_eq_u32 vcc, 3, v1
    s_nop 1
    v_cndmask_b32 v96, v96, v19, vcc
    v_cndmask_b32 v96, 0, v96, s[52:53]
    v_mov_b32 v98, v96
    s_nop 1
    v_permlane32_swap_b32 v96, v98
    v_add_f32 v96, v96, v98
    v_mov_b32 v98, v96
    s_nop 1
    v_permlane16_swap_b32 v96, v98
    v_add_f32 v96, v96, v98
    v_mov_b32 v97, v20
    v_cmp_eq_u32 vcc, 1, v1
    s_nop 1
    v_cndmask_b32 v97, v97, v21, vcc
    v_cmp_eq_u32 vcc, 2, v1
    s_nop 1
    v_cndmask_b32 v97, v97, v22, vcc
    v_cmp_eq_u32 vcc, 3, v1
    s_nop 1
    v_cndmask_b32 v97, v97, v23, vcc
    v_cndmask_b32 v97, 0, v97, s[52:53]
    v_mov_b32 v98, v97
    s_nop 1
    v_permlane32_swap_b32 v97, v98
    v_add_f32 v97, v97, v98
    v_mov_b32 v98, v97
    s_nop 1
    v_permlane16_swap_b32 v97, v98
    v_add_f32 v97, v97, v98
K3_C2:
    ds_read_b64_tr_b16 v[32:33], v15
    ds_read_b64_tr_b16 v[34:35], v15 offset:512
    v_and_b32 v5, 7, v9
    v_lshrrev_b32 v6, 1, v5
    v_and_b32 v5, 1, v5
    v_lshlrev_b32 v6, 10, v6
    v_lshl_add_u32 v6, v5, 8, v6
    v_lshl_add_u32 v6, v10, 4, v6
    s_lshl_b32 s3, s10, 7
    s_add_u32 s3, s3, 131072
    v_add_u32 v6, s3, v6
    ds_read_b128 v[104:107], v6
    ds_read_b128 v[108:111], v6 offset:64
    s_lshl_b32 s3, s8, 7
    v_lshlrev_b32 v5, 2, v9
    v_add_u32 v5, 151552, v5
    v_add_u32 v6, s3, v5
    s_lshl_b32 s3, s9, 8
    s_lshl_b32 s12, s11, 6
    s_add_u32 s3, s3, s12
    v_add_u32 v5, s3, v5
    v_lshlrev_b32 v1, 4, v2
    v_add_u32 v1, 135168, v1
    s_lshl_b32 s3, s8, 11
    v_add_u32 v3, s3, v1
    s_xor_b32 s3, s8, 4
    s_lshl_b32 s3, s3, 11
    v_add_u32 v4, s3, v1
    s_cmp_eq_u32 s11, 0
    s_cselect_b64 vcc, -1, 0
    v_cndmask_b32 v112, v80, v88, vcc
    v_cndmask_b32 v80, v88, v80, vcc
    v_cndmask_b32 v113, v81, v89, vcc
    v_cndmask_b32 v81, v89, v81, vcc
    v_cndmask_b32 v114, v82, v90, vcc
    v_cndmask_b32 v82, v90, v82, vcc
    v_cndmask_b32 v115, v83, v91, vcc
    v_cndmask_b32 v83, v91, v83, vcc
    v_cndmask_b32 v116, v84, v92, vcc
    v_cndmask_b32 v84, v92, v84, vcc
    v_cndmask_b32 v117, v85, v93, vcc
    v_cndmask_b32 v85, v93, v85, vcc
    v_cndmask_b32 v118, v86, v94, vcc
    v_cndmask_b32 v86, v94, v86, vcc
    v_cndmask_b32 v119, v87, v95, vcc
    v_cndmask_b32 v87, v95, v87, vcc
    ds_write_b128 v3, v[112:115]
    ds_write_b128 v3, v[116:119] offset:1024
    ds_write_b32 v6, v96
    ds_write_b32 v6, v97 offset:64
    s_waitcnt lgkmcnt(0)
    s_barrier
    ds_read_b128 v[112:115], v4
    ds_read_b128 v[116:119], v4 offset:1024
    ds_read_b32 v96, v5 offset:0
    ds_read_b32 v97, v5 offset:512
    ds_read_b32 v98, v5 offset:128
    ds_read_b32 v99, v5 offset:640
    s_waitcnt lgkmcnt(0)
    v_add_f32 v80, v80, v112
    v_add_f32 v81, v81, v113
    v_add_f32 v82, v82, v114
    v_add_f32 v83, v83, v115
    v_add_f32 v84, v84, v116
    v_add_f32 v85, v85, v117
    v_add_f32 v86, v86, v118
    v_add_f32 v87, v87, v119
    v_add_f32 v96, v96, v97
    v_add_f32 v98, v98, v99
    v_mul_f32 v112, s21, v96
    v_mul_f32 v114, s21, v98
    v_fma_f32 v114, -v112, v112, v114
    v_max_f32 v114, 0, v114
    v_mov_b32 v118, v114
    v_cvt_pk_bf16_f32 v118, v118, v118
    v_lshlrev_b32 v118, 16, v118
    v_add_f32 v118, s22, v118
    v_cvt_pk_bf16_f32 v118, v118, v118
    v_lshlrev_b32 v118, 16, v118
    v_sqrt_f32 v118, v118
    s_nop 0
    v_cvt_pk_bf16_f32 v118, v118, v118
    v_lshlrev_b32 v118, 16, v118
    v_cvt_pk_bf16_f32 v116, v112, v112
    v_lshlrev_b32 v116, 16, v116
    v_rcp_f32 v120, v118
    v_sub_f32 v112, v112, v116
    v_mul_f32 v112, v112, v120
    v_mul_f32 v114, v114, v120
    v_mul_f32 v114, v114, v120
    v_cvt_pk_bf16_f32 v112, v112, v112
    v_lshlrev_b32 v112, 16, v112
    v_cvt_pk_bf16_f32 v114, v114, v114
    v_lshlrev_b32 v114, 16, v114
    v_add_f32 v114, s22, v114
    v_cvt_pk_bf16_f32 v114, v114, v114
    v_lshlrev_b32 v114, 16, v114
    v_sqrt_f32 v114, v114
    s_nop 0
    v_cvt_pk_bf16_f32 v114, v114, v114
    v_lshlrev_b32 v114, 16, v114
    v_fma_f32 v112, v112, v118, v116
    v_sub_f32 v112, 0, v112
    v_mov_b32 v113, v112
    v_mul_f32 v114, v114, v118
    v_rcp_f32 v114, v114
    v_sub_f32 v116, 0, v116
    v_mov_b32 v117, v116
    v_mov_b32 v121, v120
    v_mov_b32 v115, v114
    s_add_u32 s44, s32, 12582912
    s_addc_u32 s45, s33, 0
    s_add_u32 s46, s32, 14680064
    s_addc_u32 s47, s33, 0
    s_add_u32 s48, s32, 16781312
    s_addc_u32 s49, s33, 0
    s_lshl_b32 s3, s9, 5
    s_lshl_b32 s12, s11, 4
    s_add_u32 s3, s3, s12
    v_add_u32 v5, s3, v9
    v_mul_u32_u24 v5, 144, v5
    v_lshl_add_u32 v5, v10, 3, v5
    s_lshl_b32 s3, s10, 6
    s_add_u32 s3, s3, 36864
    v_add_u32 v5, s3, v5
    v_lshrrev_b32 v1, 3, v2
    s_lshl_b32 s3, s8, 3
    v_add_u32 v1, s3, v1
    v_and_b32 v7, 7, v2
    v_mul_u32_u24 v6, 144, v1
    v_lshl_add_u32 v6, v7, 4, v6
    v_add_u32 v6, 36864, v6
    s_lshl_b32 s3, s4, 6
    v_add_u32 v1, s3, v1
    v_lshlrev_b32 v1, 10, v1
    v_lshl_add_u32 v7, v7, 4, v1
    s_lshl_b32 s3, s5, 7
    v_add_u32 v7, s3, v7
    v_lshl_add_u32 v8, v10, 3, v5
    v_add_f32_dpp v104, v104, v104 quad_perm:[1,0,3,2] row_mask:0xf bank_mask:0xf
    v_add_f32_dpp v105, v105, v105 quad_perm:[1,0,3,2] row_mask:0xf bank_mask:0xf
    v_add_f32_dpp v106, v106, v106 quad_perm:[1,0,3,2] row_mask:0xf bank_mask:0xf
    v_add_f32_dpp v107, v107, v107 quad_perm:[1,0,3,2] row_mask:0xf bank_mask:0xf
    v_add_f32_dpp v108, v108, v108 quad_perm:[1,0,3,2] row_mask:0xf bank_mask:0xf
    v_add_f32_dpp v109, v109, v109 quad_perm:[1,0,3,2] row_mask:0xf bank_mask:0xf
    v_add_f32_dpp v110, v110, v110 quad_perm:[1,0,3,2] row_mask:0xf bank_mask:0xf
    v_add_f32_dpp v111, v111, v111 quad_perm:[1,0,3,2] row_mask:0xf bank_mask:0xf
    v_add_f32_dpp v104, v104, v104 quad_perm:[2,3,0,1] row_mask:0xf bank_mask:0xf
    v_add_f32_dpp v105, v105, v105 quad_perm:[2,3,0,1] row_mask:0xf bank_mask:0xf
    v_add_f32_dpp v106, v106, v106 quad_perm:[2,3,0,1] row_mask:0xf bank_mask:0xf
    v_add_f32_dpp v107, v107, v107 quad_perm:[2,3,0,1] row_mask:0xf bank_mask:0xf
    v_add_f32_dpp v108, v108, v108 quad_perm:[2,3,0,1] row_mask:0xf bank_mask:0xf
    v_add_f32_dpp v109, v109, v109 quad_perm:[2,3,0,1] row_mask:0xf bank_mask:0xf
    v_add_f32_dpp v110, v110, v110 quad_perm:[2,3,0,1] row_mask:0xf bank_mask:0xf
    v_add_f32_dpp v111, v111, v111 quad_perm:[2,3,0,1] row_mask:0xf bank_mask:0xf
    v_add_f32_dpp v104, v104, v104 row_half_mirror row_mask:0xf bank_mask:0xf
    v_add_f32_dpp v105, v105, v105 row_half_mirror row_mask:0xf bank_mask:0xf
    v_add_f32_dpp v106, v106, v106 row_half_mirror row_mask:0xf bank_mask:0xf
    v_add_f32_dpp v107, v107, v107 row_half_mirror row_mask:0xf bank_mask:0xf
    v_add_f32_dpp v108, v108, v108 row_half_mirror row_mask:0xf bank_mask:0xf
    v_add_f32_dpp v109, v109, v109 row_half_mirror row_mask:0xf bank_mask:0xf
    v_add_f32_dpp v110, v110, v110 row_half_mirror row_mask:0xf bank_mask:0xf
    v_add_f32_dpp v111, v111, v111 row_half_mirror row_mask:0xf bank_mask:0xf
    ds_write_b128 v8, v[32:35] offset:9216
    v_pk_fma_f32 v[80:81], v[104:105], v[112:113], v[80:81]
    v_pk_fma_f32 v[82:83], v[106:107], v[112:113], v[82:83]
    v_pk_mul_f32 v[80:81], v[80:81], v[114:115]
    v_pk_mul_f32 v[82:83], v[82:83], v[114:115]
    v_cvt_pk_bf16_f32 v64, v80, v81
    v_cvt_pk_bf16_f32 v65, v82, v83
    v_lshlrev_b32 v80, 16, v64
    v_and_b32 v81, s23, v64
    v_lshlrev_b32 v82, 16, v65
    v_and_b32 v83, s23, v65
    v_pk_mul_f32 v[64:65], v[80:81], v[80:81]
    v_pk_mul_f32 v[66:67], v[82:83], v[82:83]
    v_pk_fma_f32 v[64:65], v[64:65], s[26:27], v[30:31]
    v_pk_fma_f32 v[66:67], v[66:67], s[26:27], v[30:31]
    v_pk_mul_f32 v[64:65], v[64:65], v[80:81]
    v_pk_mul_f32 v[66:67], v[66:67], v[82:83]
    v_exp_f32 v64, v64
    v_exp_f32 v65, v65
    v_exp_f32 v66, v66
    v_exp_f32 v67, v67
    v_pk_add_f32 v[64:65], v[64:65], 1.0 op_sel_hi:[1,0]
    v_pk_add_f32 v[66:67], v[66:67], 1.0 op_sel_hi:[1,0]
    v_rcp_f32 v64, v64
    v_rcp_f32 v65, v65
    v_rcp_f32 v66, v66
    v_rcp_f32 v67, v67
    v_pk_mul_f32 v[80:81], v[80:81], v[64:65]
    v_pk_mul_f32 v[82:83], v[82:83], v[66:67]
    v_cvt_pk_bf16_f32 v56, v80, v81
    v_cvt_pk_bf16_f32 v57, v82, v83
    ds_write_b64 v5, v[56:57] offset:0
    v_pk_fma_f32 v[84:85], v[108:109], v[112:113], v[84:85]
    v_pk_fma_f32 v[86:87], v[110:111], v[112:113], v[86:87]
    v_pk_mul_f32 v[84:85], v[84:85], v[114:115]
    v_pk_mul_f32 v[86:87], v[86:87], v[114:115]
    v_cvt_pk_bf16_f32 v72, v84, v85
    v_cvt_pk_bf16_f32 v73, v86, v87
    v_lshlrev_b32 v84, 16, v72
    v_and_b32 v85, s23, v72
    v_lshlrev_b32 v86, 16, v73
    v_and_b32 v87, s23, v73
    v_pk_mul_f32 v[72:73], v[84:85], v[84:85]
    v_pk_mul_f32 v[74:75], v[86:87], v[86:87]
    v_pk_fma_f32 v[72:73], v[72:73], s[26:27], v[30:31]
    v_pk_fma_f32 v[74:75], v[74:75], s[26:27], v[30:31]
    v_pk_mul_f32 v[72:73], v[72:73], v[84:85]
    v_pk_mul_f32 v[74:75], v[74:75], v[86:87]
    v_exp_f32 v72, v72
    v_exp_f32 v73, v73
    v_exp_f32 v74, v74
    v_exp_f32 v75, v75
    v_pk_add_f32 v[72:73], v[72:73], 1.0 op_sel_hi:[1,0]
    v_pk_add_f32 v[74:75], v[74:75], 1.0 op_sel_hi:[1,0]
    v_rcp_f32 v72, v72
    v_rcp_f32 v73, v73
    v_rcp_f32 v74, v74
    v_rcp_f32 v75, v75
    v_pk_mul_f32 v[84:85], v[84:85], v[72:73]
    v_pk_mul_f32 v[86:87], v[86:87], v[74:75]
    v_cvt_pk_bf16_f32 v58, v84, v85
    v_cvt_pk_bf16_f32 v59, v86, v87
    ds_write_b64 v5, v[58:59] offset:32
    v_lshlrev_b32 v96, 16, v32
    v_and_b32 v97, s23, v32
    v_pk_add_f32 v[96:97], v[96:97], v[116:117]
    v_cvt_pk_bf16_f32 v98, v96, v97
    v_lshlrev_b32 v96, 16, v98
    v_and_b32 v97, s23, v98
    v_pk_mul_f32 v[96:97], v[96:97], v[120:121]
    v_cvt_pk_bf16_f32 v36, v96, v97
    v_lshlrev_b32 v96, 16, v33
    v_and_b32 v97, s23, v33
    v_pk_add_f32 v[96:97], v[96:97], v[116:117]
    v_cvt_pk_bf16_f32 v98, v96, v97
    v_lshlrev_b32 v96, 16, v98
    v_and_b32 v97, s23, v98
    v_pk_mul_f32 v[96:97], v[96:97], v[120:121]
    v_cvt_pk_bf16_f32 v37, v96, v97
    v_lshlrev_b32 v96, 16, v34
    v_and_b32 v97, s23, v34
    v_pk_add_f32 v[96:97], v[96:97], v[116:117]
    v_cvt_pk_bf16_f32 v98, v96, v97
    v_lshlrev_b32 v96, 16, v98
    v_and_b32 v97, s23, v98
    v_pk_mul_f32 v[96:97], v[96:97], v[120:121]
    v_cvt_pk_bf16_f32 v38, v96, v97
    v_lshlrev_b32 v96, 16, v35
    v_and_b32 v97, s23, v35
    v_pk_add_f32 v[96:97], v[96:97], v[116:117]
    v_cvt_pk_bf16_f32 v98, v96, v97
    v_lshlrev_b32 v96, 16, v98
    v_and_b32 v97, s23, v98
    v_pk_mul_f32 v[96:97], v[96:97], v[120:121]
    v_cvt_pk_bf16_f32 v39, v96, v97
    ds_write_b128 v8, v[36:39] offset:18432
    s_waitcnt lgkmcnt(0)
    s_barrier
    ds_read_b128 v[32:35], v6
    ds_read_b128 v[36:39], v6 offset:9216
    ds_read_b128 v[40:43], v6 offset:18432
    s_waitcnt lgkmcnt(2)
    global_store_dwordx4 v7, v[32:35], s[48:49] sc1
    s_waitcnt lgkmcnt(1)
    global_store_dwordx4 v7, v[36:39], s[44:45] sc1
    s_waitcnt lgkmcnt(0)
    global_store_dwordx4 v7, v[40:43], s[46:47] sc1
K3_CODE_END:
K3_END:
    s_endpgm
.globl k4_kernel
.p2align 8
.type k4_kernel,@function
k4_kernel:
    s_cmp_ge_u32 s2, 256
    s_cbranch_scc1 K4_END
    s_load_dwordx8 s[64:71], s[0:1], 80
    s_load_dwordx4 s[72:75], s[0:1], 112
    s_load_dwordx2 s[32:33], s[0:1], 128
    v_lshrrev_b32 v1, 6, v0
    s_nop 0
    v_readfirstlane_b32 s8, v1
    v_and_b32 v2, 63, v0
    v_and_b32 v9, 15, v0
    v_bfe_u32 v10, v0, 4, 2
    s_waitcnt lgkmcnt(0)
    s_cmp_ge_u32 s8, 4
    s_cbranch_scc1 K4_C
    s_getpc_b64 s[76:77]
K4_PC:
    v_lshlrev_b32 v1, 4, v0
    global_load_dwordx4 v[120:123], v1, s[76:77]
    v_add_u32 v1, 0x1000, v1
    v_cmp_gt_u32 vcc, K4_CODE_END-K4_PC-16, v1
    s_and_saveexec_b64 s[78:79], vcc
    s_cbranch_execz K4_NOPF
    global_load_dwordx4 v[124:127], v1, s[76:77]
K4_NOPF:
    s_mov_b64 exec, -1
    s_mov_b32 s16, s66
    s_mov_b32 s17, s67
    s_and_b32 s4, s2, 7
    s_lshl_b32 s4, s4, 2
    s_lshr_b32 s5, s2, 6
    s_add_u32 s4, s4, s5
    s_bfe_u32 s5, s2, 0x30003
    v_lshrrev_b32 v4, 3, v2
    v_bfe_u32 v5, v2, 4, 1
    v_lshlrev_b32 v5, 1, v5
    s_and_b32 s3, s8, 1
    s_lshl_b32 s3, s3, 2
    v_or_b32 v5, s3, v5
    v_and_b32 v1, 7, v2
    v_xor_b32 v5, v1, v5
    v_mul_u32_u24 v4, 1024, v4
    v_lshl_add_u32 v4, v5, 4, v4
    s_lshl_b32 s3, s8, 2
    v_add_u32 v1, s3, v10
    v_xor_b32 v1, v9, v1
    v_lshlrev_b32 v3, 10, v10
    v_lshl_add_u32 v3, v1, 4, v3
    s_lshl_b32 s7, s5, 7
    s_lshl_b32 s3, s8, 13
    s_add_u32 s7, s7, s3
    s_lshl_b32 s6, s4, 16
    s_lshl_b32 s3, s8, 12
    s_add_u32 s6, s6, s3
    s_lshl_b32 s15, s8, 10
    s_lshl_b32 s13, s4, 16
    s_lshl_b32 s3, s8, 13
    s_add_u32 s13, s13, s3
    s_lshl_b32 s3, s5, 7
    s_add_u32 s13, s13, s3
    s_waitcnt lgkmcnt(0)
    v_lshrrev_b32 v6, 3, v2
    v_lshlrev_b32 v6, 10, v6
    v_and_b32 v1, 7, v2
    v_lshl_add_u32 v6, v1, 4, v6
    s_add_u32 s36, s32, 16779264
    s_addc_u32 s37, s33, 0
    s_mov_b32 s38, 2101248
    s_mov_b32 s39, 0x00020000
    s_add_u32 s40, s16, 0
    s_addc_u32 s41, s17, 0
    s_mov_b32 s42, 524288
    s_mov_b32 s43, 0x00020000
    s_add_u32 s44, s32, 14680064
    s_addc_u32 s45, s33, 0
    s_mov_b32 s46, 2097152
    s_mov_b32 s47, 0x00020000
    s_add_u32 m0, s15, 65536
    s_nop 0
    buffer_load_dwordx4 v3, s[36:39], s6 offen lds
    s_add_u32 m0, s15, 0
    s_nop 0
    buffer_load_dwordx4 v4, s[40:43], s7 offen lds
    s_add_u32 m0, s15, 69632
    s_add_u32 s3, s6, 16384
    buffer_load_dwordx4 v3, s[36:39], s3 offen lds
    s_add_u32 m0, s15, 4096
    s_add_u32 s3, s7, 32768
    buffer_load_dwordx4 v4, s[40:43], s3 offen lds
    s_add_u32 m0, s15, 73728
    s_add_u32 s3, s6, 32768
    buffer_load_dwordx4 v3, s[36:39], s3 offen lds
    s_add_u32 m0, s15, 8192
    s_add_u32 s3, s7, 65536
    buffer_load_dwordx4 v4, s[40:43], s3 offen lds
    s_add_u32 m0, s15, 77824
    s_add_u32 s3, s6, 49152
    buffer_load_dwordx4 v3, s[36:39], s3 offen lds
    s_add_u32 m0, s15, 12288
    s_add_u32 s3, s7, 98304
    buffer_load_dwordx4 v4, s[40:43], s3 offen lds
    s_add_u32 m0, s15, 81920
    s_add_u32 s3, s6, 65536
    buffer_load_dwordx4 v3, s[36:39], s3 offen lds
    s_add_u32 m0, s15, 86016
    s_add_u32 s3, s6, 256
    buffer_load_dwordx4 v3, s[36:39], s3 offen lds
    s_add_u32 m0, s15, 16384
    s_add_u32 s3, s7, 131072
    buffer_load_dwordx4 v4, s[40:43], s3 offen lds
    s_add_u32 m0, s15, 90112
    s_add_u32 s3, s6, 16640
    buffer_load_dwordx4 v3, s[36:39], s3 offen lds
    s_add_u32 m0, s15, 20480
    s_add_u32 s3, s7, 163840
    buffer_load_dwordx4 v4, s[40:43], s3 offen lds
    s_add_u32 m0, s15, 94208
    s_add_u32 s3, s6, 33024
    buffer_load_dwordx4 v3, s[36:39], s3 offen lds
    s_add_u32 m0, s15, 24576
    s_add_u32 s3, s7, 196608
    buffer_load_dwordx4 v4, s[40:43], s3 offen lds
    s_add_u32 m0, s15, 98304
    s_add_u32 s3, s6, 49408
    buffer_load_dwordx4 v3, s[36:39], s3 offen lds
    s_add_u32 m0, s15, 28672
    s_add_u32 s3, s7, 229376
    buffer_load_dwordx4 v4, s[40:43], s3 offen lds
    s_add_u32 m0, s15, 102400
    s_add_u32 s3, s6, 65792
    buffer_load_dwordx4 v3, s[36:39], s3 offen lds
    s_waitcnt vmcnt(9)
    s_barrier
    s_add_u32 m0, s15, 106496
    s_add_u32 s3, s6, 512
    buffer_load_dwordx4 v3, s[36:39], s3 offen lds
    s_add_u32 m0, s15, 32768
    s_add_u32 s3, s7, 262144
    buffer_load_dwordx4 v4, s[40:43], s3 offen lds
    s_add_u32 m0, s15, 110592
    s_add_u32 s3, s6, 16896
    buffer_load_dwordx4 v3, s[36:39], s3 offen lds
    s_add_u32 m0, s15, 36864
    s_add_u32 s3, s7, 294912
    buffer_load_dwordx4 v4, s[40:43], s3 offen lds
    s_add_u32 m0, s15, 114688
    s_add_u32 s3, s6, 33280
    buffer_load_dwordx4 v3, s[36:39], s3 offen lds
    s_add_u32 m0, s15, 40960
    s_add_u32 s3, s7, 327680
    buffer_load_dwordx4 v4, s[40:43], s3 offen lds
    s_add_u32 m0, s15, 118784
    s_add_u32 s3, s6, 49664
    buffer_load_dwordx4 v3, s[36:39], s3 offen lds
    s_add_u32 m0, s15, 45056
    s_add_u32 s3, s7, 360448
    buffer_load_dwordx4 v4, s[40:43], s3 offen lds
    s_add_u32 m0, s15, 122880
    s_add_u32 s3, s6, 66048
    buffer_load_dwordx4 v3, s[36:39], s3 offen lds
    s_waitcnt vmcnt(9)
    s_barrier
    s_add_u32 m0, s15, 126976
    s_add_u32 s3, s6, 768
    buffer_load_dwordx4 v3, s[36:39], s3 offen lds
    s_add_u32 m0, s15, 49152
    s_add_u32 s3, s7, 393216
    buffer_load_dwordx4 v4, s[40:43], s3 offen lds
    s_add_u32 m0, s15, 131072
    s_add_u32 s3, s6, 17152
    buffer_load_dwordx4 v3, s[36:39], s3 offen lds
    s_add_u32 m0, s15, 53248
    s_add_u32 s3, s7, 425984
    buffer_load_dwordx4 v4, s[40:43], s3 offen lds
    s_add_u32 m0, s15, 135168
    s_add_u32 s3, s6, 33536
    buffer_load_dwordx4 v3, s[36:39], s3 offen lds
    s_add_u32 m0, s15, 57344
    s_add_u32 s3, s7, 458752
    buffer_load_dwordx4 v4, s[40:43], s3 offen lds
    s_add_u32 m0, s15, 139264
    s_add_u32 s3, s6, 49920
    buffer_load_dwordx4 v3, s[36:39], s3 offen lds
    s_add_u32 m0, s15, 61440
    s_add_u32 s3, s7, 491520
    buffer_load_dwordx4 v4, s[40:43], s3 offen lds
    s_add_u32 m0, s15, 143360
    s_add_u32 s3, s6, 66304
    buffer_load_dwordx4 v3, s[36:39], s3 offen lds
    s_add_u32 m0, s15, 147456
    s_nop 0
    buffer_load_dwordx4 v6, s[44:47], s13 offen lds
    s_add_u32 m0, s15, 151552
    s_add_u32 s3, s13, 32768
    buffer_load_dwordx4 v6, s[44:47], s3 offen lds
    s_waitcnt vmcnt(11)
    s_barrier
    s_waitcnt vmcnt(0)
    s_barrier
    s_endpgm
K4_C:
    s_sub_u32 s8, s8, 4
    s_and_b32 s4, s2, 7
    s_lshl_b32 s4, s4, 2
    s_lshr_b32 s5, s2, 6
    s_add_u32 s4, s4, s5
    s_bfe_u32 s5, s2, 0x30003
    s_mov_b32 s20, 0x3f803f80
    s_mov_b32 s21, 0x3b000000
    s_mov_b32 s22, 0x3727c5ac
    s_mov_b32 s23, 0xffff0000
    s_mov_b32 s24, 0xc0135761
    s_mov_b32 s25, 0xbdd2d3e8
    s_bfe_u32 s9, s8, 0x10001
    s_and_b32 s10, s8, 1
    s_lshr_b32 s11, s8, 2
    s_lshl_b32 s14, s10, 2
    s_add_u32 s15, s14, 2
    s_lshl_b32 s28, s11, 12
    s_lshl_b32 s29, s11, 6
    v_bfe_u32 v5, v9, 3, 1
    v_lshlrev_b32 v5, 1, v5
    v_and_b32 v3, 1, v10
    v_lshl_or_b32 v5, v3, 2, v5
    v_bfe_u32 v3, v9, 1, 1
    v_add_u32 v3, s14, v3
    v_xor_b32 v5, v5, v3
    v_lshlrev_b32 v5, 4, v5
    v_and_b32 v3, 1, v9
    v_lshl_add_u32 v5, v3, 3, v5
    v_lshrrev_b32 v3, 2, v9
    v_lshl_add_u32 v3, v10, 3, v3
    v_lshl_add_u32 v13, v3, 7, v5
    v_add_u32 v13, 0, v13
    v_bfe_u32 v5, v9, 3, 1
    v_lshlrev_b32 v5, 1, v5
    v_and_b32 v3, 1, v10
    v_lshl_or_b32 v5, v3, 2, v5
    v_bfe_u32 v3, v9, 1, 1
    v_add_u32 v3, s15, v3
    v_xor_b32 v5, v5, v3
    v_lshlrev_b32 v5, 4, v5
    v_and_b32 v3, 1, v9
    v_lshl_add_u32 v5, v3, 3, v5
    v_lshrrev_b32 v3, 2, v9
    v_lshl_add_u32 v3, v10, 3, v3
    v_lshl_add_u32 v14, v3, 7, v5
    v_add_u32 v14, 0, v14
    v_add_u32 v13, s28, v13
    v_add_u32 v14, s28, v14
    s_lshl_b32 s3, s9, 5
    s_add_u32 s3, s3, 1
    v_add_u32 v5, s3, v9
    v_and_b32 v3, 15, v5
    v_xor_b32 v3, v10, v3
    v_lshlrev_b32 v3, 4, v3
    v_lshl_add_u32 v100, v5, 8, v3
    v_add_u32 v100, 65536, v100
    v_xor_b32 v100, s29, v100
    v_xor_b32 v101, 0x80, v100
    s_lshl_b32 s3, s9, 5
    s_add_u32 s3, s3, 3
    v_add_u32 v5, s3, v9
    v_and_b32 v3, 15, v5
    v_xor_b32 v3, v10, v3
    v_lshlrev_b32 v3, 4, v3
    v_lshl_add_u32 v102, v5, 8, v3
    v_add_u32 v102, 86016, v102
    v_xor_b32 v102, s29, v102
    v_xor_b32 v103, 0x80, v102
    s_lshl_b32 s3, s9, 5
    s_add_u32 s3, s3, 0
    v_add_u32 v5, s3, v9
    v_and_b32 v3, 15, v5
    v_xor_b32 v3, v10, v3
    v_lshlrev_b32 v3, 4, v3
    v_lshl_add_u32 v104, v5, 8, v3
    v_add_u32 v104, 106496, v104
    v_xor_b32 v104, s29, v104
    v_xor_b32 v105, 0x80, v104
    s_lshl_b32 s3, s9, 5
    s_add_u32 s3, s3, 4
    v_add_u32 v5, s3, v9
    v_and_b32 v3, 15, v5
    v_xor_b32 v3, v10, v3
    v_lshlrev_b32 v3, 4, v3
    v_lshl_add_u32 v106, v5, 8, v3
    v_add_u32 v106, 126976, v106
    v_xor_b32 v106, s29, v106
    v_xor_b32 v107, 0x80, v106
    v_mov_b32 v80, 0
    v_mov_b32 v81, 0
    v_mov_b32 v82, 0
    v_mov_b32 v83, 0
    v_mov_b32 v84, 0
    v_mov_b32 v85, 0
    v_mov_b32 v86, 0
    v_mov_b32 v87, 0
    v_mov_b32 v88, 0
    v_mov_b32 v89, 0
    v_mov_b32 v90, 0
    v_mov_b32 v91, 0
    v_mov_b32 v92, 0
    v_mov_b32 v93, 0
    v_mov_b32 v94, 0
    v_mov_b32 v95, 0
    s_barrier
    ds_read_b128 v[32:35], v100 offset:0
    ds_read_b128 v[36:39], v100 offset:4096
    ds_read_b64_tr_b16 v[56:57], v13 offset:0
    ds_read_b64_tr_b16 v[58:59], v13 offset:512
    ds_read_b64_tr_b16 v[60:61], v14 offset:0
    ds_read_b64_tr_b16 v[62:63], v14 offset:512
    ds_read_b128 v[40:43], v101 offset:0
    ds_read_b128 v[44:47], v101 offset:4096
    ds_read_b64_tr_b16 v[64:65], v13 offset:8192
    ds_read_b64_tr_b16 v[66:67], v13 offset:8704
    ds_read_b64_tr_b16 v[68:69], v14 offset:8192
    ds_read_b64_tr_b16 v[70:71], v14 offset:8704
    s_waitcnt lgkmcnt(6)
    v_mfma_f32_16x16x32_bf16 v[80:83], v[56:59], v[32:35], v[80:83]
    v_mfma_f32_16x16x32_bf16 v[84:87], v[60:63], v[32:35], v[84:87]
    v_mfma_f32_16x16x32_bf16 v[88:91], v[56:59], v[36:39], v[88:91]
    v_mfma_f32_16x16x32_bf16 v[92:95], v[60:63], v[36:39], v[92:95]
    s_barrier
    ds_read_b128 v[48:51], v102 offset:0
    ds_read_b128 v[52:55], v102 offset:4096
    ds_read_b64_tr_b16 v[72:73], v13 offset:16384
    ds_read_b64_tr_b16 v[74:75], v13 offset:16896
    ds_read_b64_tr_b16 v[76:77], v14 offset:16384
    ds_read_b64_tr_b16 v[78:79], v14 offset:16896
    s_waitcnt lgkmcnt(6)
    v_mfma_f32_16x16x32_bf16 v[80:83], v[64:67], v[40:43], v[80:83]
    v_mfma_f32_16x16x32_bf16 v[84:87], v[68:71], v[40:43], v[84:87]
    v_mfma_f32_16x16x32_bf16 v[88:91], v[64:67], v[44:47], v[88:91]
    v_mfma_f32_16x16x32_bf16 v[92:95], v[68:71], v[44:47], v[92:95]
    ds_read_b128 v[32:35], v103 offset:0
    ds_read_b128 v[36:39], v103 offset:4096
    ds_read_b64_tr_b16 v[56:57], v13 offset:24576
    ds_read_b64_tr_b16 v[58:59], v13 offset:25088
    ds_read_b64_tr_b16 v[60:61], v14 offset:24576
    ds_read_b64_tr_b16 v[62:63], v14 offset:25088
    s_waitcnt lgkmcnt(6)
    v_mfma_f32_16x16x32_bf16 v[80:83], v[72:75], v[48:51], v[80:83]
    v_mfma_f32_16x16x32_bf16 v[84:87], v[76:79], v[48:51], v[84:87]
    v_mfma_f32_16x16x32_bf16 v[88:91], v[72:75], v[52:55], v[88:91]
    v_mfma_f32_16x16x32_bf16 v[92:95], v[76:79], v[52:55], v[92:95]
    s_barrier
    ds_read_b128 v[40:43], v104 offset:0
    ds_read_b128 v[44:47], v104 offset:4096
    ds_read_b64_tr_b16 v[64:65], v13 offset:32768
    ds_read_b64_tr_b16 v[66:67], v13 offset:33280
    ds_read_b64_tr_b16 v[68:69], v14 offset:32768
    ds_read_b64_tr_b16 v[70:71], v14 offset:33280
    s_waitcnt lgkmcnt(6)
    v_mfma_f32_16x16x32_bf16 v[80:83], v[56:59], v[32:35], v[80:83]
    v_mfma_f32_16x16x32_bf16 v[84:87], v[60:63], v[32:35], v[84:87]
    v_mfma_f32_16x16x32_bf16 v[88:91], v[56:59], v[36:39], v[88:91]
    v_mfma_f32_16x16x32_bf16 v[92:95], v[60:63], v[36:39], v[92:95]
    ds_read_b128 v[48:51], v105 offset:0
    ds_read_b128 v[52:55], v105 offset:4096
    ds_read_b64_tr_b16 v[72:73], v13 offset:40960
    ds_read_b64_tr_b16 v[74:75], v13 offset:41472
    ds_read_b64_tr_b16 v[76:77], v14 offset:40960
    ds_read_b64_tr_b16 v[78:79], v14 offset:41472
    s_waitcnt lgkmcnt(6)
    v_mfma_f32_16x16x32_bf16 v[80:83], v[64:67], v[40:43], v[80:83]
    v_mfma_f32_16x16x32_bf16 v[84:87], v[68:71], v[40:43], v[84:87]
    v_mfma_f32_16x16x32_bf16 v[88:91], v[64:67], v[44:47], v[88:91]
    v_mfma_f32_16x16x32_bf16 v[92:95], v[68:71], v[44:47], v[92:95]
    s_barrier
    ds_read_b128 v[32:35], v106 offset:0
    ds_read_b128 v[36:39], v106 offset:4096
    ds_read_b64_tr_b16 v[56:57], v13 offset:49152
    ds_read_b64_tr_b16 v[58:59], v13 offset:49664
    ds_read_b64_tr_b16 v[60:61], v14 offset:49152
    ds_read_b64_tr_b16 v[62:63], v14 offset:49664
    s_waitcnt lgkmcnt(6)
    v_mfma_f32_16x16x32_bf16 v[80:83], v[72:75], v[48:51], v[80:83]
    v_mfma_f32_16x16x32_bf16 v[84:87], v[76:79], v[48:51], v[84:87]
    v_mfma_f32_16x16x32_bf16 v[88:91], v[72:75], v[52:55], v[88:91]
    v_mfma_f32_16x16x32_bf16 v[92:95], v[76:79], v[52:55], v[92:95]
    ds_read_b128 v[40:43], v107 offset:0
    ds_read_b128 v[44:47], v107 offset:4096
    ds_read_b64_tr_b16 v[64:65], v13 offset:57344
    ds_read_b64_tr_b16 v[66:67], v13 offset:57856
    ds_read_b64_tr_b16 v[68:69], v14 offset:57344
    ds_read_b64_tr_b16 v[70:71], v14 offset:57856
    s_waitcnt lgkmcnt(6)
    v_mfma_f32_16x16x32_bf16 v[80:83], v[56:59], v[32:35], v[80:83]
    v_mfma_f32_16x16x32_bf16 v[84:87], v[60:63], v[32:35], v[84:87]
    v_mfma_f32_16x16x32_bf16 v[88:91], v[56:59], v[36:39], v[88:91]
    v_mfma_f32_16x16x32_bf16 v[92:95], v[60:63], v[36:39], v[92:95]
    s_waitcnt lgkmcnt(0)
    v_mfma_f32_16x16x32_bf16 v[80:83], v[64:67], v[40:43], v[80:83]
    v_mfma_f32_16x16x32_bf16 v[84:87], v[68:71], v[40:43], v[84:87]
    v_mfma_f32_16x16x32_bf16 v[88:91], v[64:67], v[44:47], v[88:91]
    v_mfma_f32_16x16x32_bf16 v[92:95], v[68:71], v[44:47], v[92:95]
    s_lshl_b32 s3, s9, 5
    s_lshl_b32 s12, s11, 4
    s_add_u32 s12, s3, s12
    v_add_u32 v8, s12, v9
    v_lshlrev_b32 v5, 7, v8
    v_lshl_add_u32 v5, v10, 3, v5
    s_lshl_b32 s3, s10, 6
    s_add_u32 s3, s3, 147456
    v_add_u32 v5, s3, v5
    ds_read_b64 v[96:97], v5
    ds_read_b64 v[98:99], v5 offset:32
    s_lshl_b32 s3, s4, 13
    s_lshl_b32 s12, s5, 10
    s_add_u32 s3, s3, s12
    s_lshl_b32 s12, s10, 9
    s_add_u32 s3, s3, s12
    v_lshlrev_b32 v8, 3, v8
    v_add_u32 v8, s3, v8
    s_barrier
    v_lshlrev_b32 v1, 4, v2
    v_add_u32 v1, 0, v1
    s_lshl_b32 s3, s8, 12
    v_add_u32 v3, s3, v1
    s_xor_b32 s3, s8, 4
    s_lshl_b32 s3, s3, 12
    v_add_u32 v4, s3, v1
    s_cmp_eq_u32 s11, 0
    s_cselect_b64 vcc, -1, 0
    v_cndmask_b32 v108, v80, v88, vcc
    v_cndmask_b32 v80, v88, v80, vcc
    v_cndmask_b32 v109, v81, v89, vcc
    v_cndmask_b32 v81, v89, v81, vcc
    v_cndmask_b32 v110, v82, v90, vcc
    v_cndmask_b32 v82, v90, v82, vcc
    v_cndmask_b32 v111, v83, v91, vcc
    v_cndmask_b32 v83, v91, v83, vcc
    v_cndmask_b32 v112, v84, v92, vcc
    v_cndmask_b32 v84, v92, v84, vcc
    v_cndmask_b32 v113, v85, v93, vcc
    v_cndmask_b32 v85, v93, v85, vcc
    v_cndmask_b32 v114, v86, v94, vcc
    v_cndmask_b32 v86, v94, v86, vcc
    v_cndmask_b32 v115, v87, v95, vcc
    v_cndmask_b32 v87, v95, v87, vcc
    ds_write_b128 v3, v[108:111]
    ds_write_b128 v3, v[112:115] offset:1024
    s_waitcnt lgkmcnt(0)
    s_barrier
    ds_read_b128 v[108:111], v4
    ds_read_b128 v[112:115], v4 offset:1024
    s_waitcnt lgkmcnt(0)
    v_add_f32 v80, v80, v108
    v_add_f32 v81, v81, v109
    v_add_f32 v82, v82, v110
    v_add_f32 v83, v83, v111
    v_add_f32 v84, v84, v112
    v_add_f32 v85, v85, v113
    v_add_f32 v86, v86, v114
    v_add_f32 v87, v87, v115
    s_add_u32 s48, s32, 18939904
    s_addc_u32 s49, s33, 0
    s_add_u32 s50, s32, 29491200
    s_addc_u32 s51, s33, 0
    s_lshl_b32 s3, s9, 5
    s_lshl_b32 s12, s11, 4
    s_add_u32 s3, s3, s12
    v_add_u32 v5, s3, v9
    v_mul_u32_u24 v5, 144, v5
    v_lshl_add_u32 v5, v10, 3, v5
    s_lshl_b32 s3, s10, 6
    s_add_u32 s3, s3, 36864
    v_add_u32 v5, s3, v5
    v_lshrrev_b32 v1, 3, v2
    s_lshl_b32 s3, s8, 3
    v_add_u32 v1, s3, v1
    v_and_b32 v7, 7, v2
    v_mul_u32_u24 v6, 144, v1
    v_lshl_add_u32 v6, v7, 4, v6
    v_add_u32 v6, 36864, v6
    s_lshl_b32 s3, s4, 6
    v_add_u32 v1, s3, v1
    v_lshlrev_b32 v1, 10, v1
    v_lshl_add_u32 v7, v7, 4, v1
    s_lshl_b32 s3, s5, 7
    v_add_u32 v7, s3, v7
    v_mov_b32 v24, 0
    v_mov_b32 v25, 0
    v_cvt_pk_bf16_f32 v26, v80, v81
    v_cvt_pk_bf16_f32 v27, v82, v83
    v_lshlrev_b32 v80, 16, v26
    v_and_b32 v81, s23, v26
    v_lshlrev_b32 v82, 16, v27
    v_and_b32 v83, s23, v27
    v_lshlrev_b32 v26, 16, v96
    v_and_b32 v27, s23, v96
    v_lshlrev_b32 v28, 16, v97
    v_and_b32 v29, s23, v97
    v_pk_add_f32 v[80:81], v[80:81], v[26:27]
    v_pk_add_f32 v[82:83], v[82:83], v[28:29]
    v_cvt_pk_bf16_f32 v56, v80, v81
    v_cvt_pk_bf16_f32 v57, v82, v83
    ds_write_b64 v5, v[56:57] offset:0
    v_dot2_f32_bf16 v24, v56, s20, v24
    v_dot2_f32_bf16 v25, v56, v56, v25
    v_dot2_f32_bf16 v24, v57, s20, v24
    v_dot2_f32_bf16 v25, v57, v57, v25
    v_cvt_pk_bf16_f32 v26, v84, v85
    v_cvt_pk_bf16_f32 v27, v86, v87
    v_lshlrev_b32 v84, 16, v26
    v_and_b32 v85, s23, v26
    v_lshlrev_b32 v86, 16, v27
    v_and_b32 v87, s23, v27
    v_lshlrev_b32 v26, 16, v98
    v_and_b32 v27, s23, v98
    v_lshlrev_b32 v28, 16, v99
    v_and_b32 v29, s23, v99
    v_pk_add_f32 v[84:85], v[84:85], v[26:27]
    v_pk_add_f32 v[86:87], v[86:87], v[28:29]
    v_cvt_pk_bf16_f32 v58, v84, v85
    v_cvt_pk_bf16_f32 v59, v86, v87
    ds_write_b64 v5, v[58:59] offset:32
    v_dot2_f32_bf16 v24, v58, s20, v24
    v_dot2_f32_bf16 v25, v58, v58, v25
    v_dot2_f32_bf16 v24, v59, s20, v24
    v_dot2_f32_bf16 v25, v59, v59, v25
    s_nop 1
    v_mov_b32 v26, v24
    s_nop 1
    v_permlane32_swap_b32 v24, v26
    v_add_f32 v24, v24, v26
    v_mov_b32 v26, v24
    s_nop 1
    v_permlane16_swap_b32 v24, v26
    v_add_f32 v24, v24, v26
    v_mov_b32 v26, v25
    s_nop 1
    v_permlane32_swap_b32 v25, v26
    v_add_f32 v25, v25, v26
    v_mov_b32 v26, v25
    s_nop 1
    v_permlane16_swap_b32 v25, v26
    v_add_f32 v25, v25, v26
    v_cmp_gt_u32 vcc, 16, v2
    s_and_saveexec_b64 s[42:43], vcc
    global_store_dwordx2 v8, v[24:25], s[50:51] sc1
    s_mov_b64 exec, s[42:43]
    s_waitcnt lgkmcnt(0)
    s_barrier
    ds_read_b128 v[32:35], v6
    s_waitcnt lgkmcnt(0)
    global_store_dwordx4 v7, v[32:35], s[48:49] sc1
K4_CODE_END:
K4_END:
    s_endpgm
.globl k5_kernel
.p2align 8
.type k5_kernel,@function
k5_kernel:
    s_cmp_ge_u32 s2, 224
    s_cbranch_scc1 K5_END
    s_load_dwordx8 s[64:71], s[0:1], 80
    s_load_dwordx4 s[72:75], s[0:1], 112
    s_load_dwordx2 s[32:33], s[0:1], 128
    v_lshrrev_b32 v1, 6, v0
    s_nop 0
    v_readfirstlane_b32 s8, v1
    v_and_b32 v2, 63, v0
    v_and_b32 v9, 15, v0
    v_bfe_u32 v10, v0, 4, 2
    s_waitcnt lgkmcnt(0)
    s_cmp_ge_u32 s8, 4
    s_cbranch_scc1 K5_C
    s_getpc_b64 s[76:77]
K5_PC:
    v_lshlrev_b32 v1, 4, v0
    global_load_dwordx4 v[120:123], v1, s[76:77]
    v_add_u32 v1, 0x1000, v1
    v_cmp_gt_u32 vcc, K5_CODE_END-K5_PC-16, v1
    s_and_saveexec_b64 s[78:79], vcc
    s_cbranch_execz K5_NOPF
    global_load_dwordx4 v[124:127], v1, s[76:77]
K5_NOPF:
    s_mov_b64 exec, -1
    s_mov_b32 s16, s68
    s_mov_b32 s17, s69
    s_and_b32 s4, s2, 7
    s_lshl_b32 s4, s4, 1
    s_lshr_b32 s5, s2, 3
    s_cmp_ge_u32 s5, 14
    s_cselect_b32 s3, 1, 0
    s_add_u32 s4, s4, s3
    s_mul_i32 s3, s3, 14
    s_sub_u32 s5, s5, s3
    s_bfe_u32 s3, s8, 0x10001
    s_lshl_b32 s3, s3, 3
    v_lshlrev_b32 v1, 1, v10
    v_or_b32 v1, s3, v1
    v_xor_b32 v1, v9, v1
    v_mul_u32_u24 v4, 3584, v10
    v_lshl_add_u32 v4, v1, 4, v4
    v_lshrrev_b32 v3, 3, v2
    v_and_b32 v1, 7, v2
    v_xor_b32 v1, v3, v1
    v_lshlrev_b32 v3, 10, v3
    v_lshl_add_u32 v3, v1, 4, v3
    v_lshlrev_b32 v5, 4, v2
    v_lshrrev_b32 v6, 5, v2
    v_mul_u32_u24 v6, 7168, v6
    v_and_b32 v1, 31, v2
    v_lshl_add_u32 v6, v1, 4, v6
    s_lshl_b32 s7, s5, 8
    s_mul_i32 s3, s8, 14336
    s_add_u32 s7, s7, s3
    s_lshl_b32 s6, s4, 17
    s_lshl_b32 s3, s8, 13
    s_add_u32 s6, s6, s3
    s_lshl_b32 s15, s8, 10
    s_lshl_b32 s12, s4, 14
    s_add_u32 s12, s12, s15
    s_add_u32 s12, s12, 29491200
    s_lshl_b32 s13, s5, 9
    s_mul_i32 s3, s8, 14336
    s_add_u32 s13, s13, s3
    s_add_u32 s13, s13, 29376512
    s_waitcnt lgkmcnt(0)
    s_add_u32 s36, s32, 18939904
    s_addc_u32 s37, s33, 0
    s_mov_b32 s38, 2097152
    s_mov_b32 s39, 0x00020000
    s_add_u32 s40, s16, 0
    s_addc_u32 s41, s17, 0
    s_mov_b32 s42, 1835008
    s_mov_b32 s43, 0x00020000
    s_add_u32 s44, s32, 0
    s_addc_u32 s45, s33, 0
    s_mov_b32 s46, 33554432
    s_mov_b32 s47, 0x00020000
    s_add_u32 m0, s15, 0
    s_nop 0
    buffer_load_dwordx4 v3, s[36:39], s6 offen lds
    s_add_u32 m0, s15, 16384
    s_nop 0
    buffer_load_dwordx4 v4, s[40:43], s7 offen lds
    s_add_u32 m0, s15, 4096
    s_add_u32 s3, s6, 32768
    buffer_load_dwordx4 v3, s[36:39], s3 offen lds
    s_add_u32 m0, s15, 20480
    s_add_u32 s3, s7, 57344
    buffer_load_dwordx4 v4, s[40:43], s3 offen lds
    s_add_u32 m0, s15, 8192
    s_add_u32 s3, s6, 65536
    buffer_load_dwordx4 v3, s[36:39], s3 offen lds
    s_add_u32 m0, s15, 24576
    s_add_u32 s3, s7, 114688
    buffer_load_dwordx4 v4, s[40:43], s3 offen lds
    s_add_u32 m0, s15, 12288
    s_add_u32 s3, s6, 98304
    buffer_load_dwordx4 v3, s[36:39], s3 offen lds
    s_add_u32 m0, s15, 28672
    s_add_u32 s3, s7, 172032
    buffer_load_dwordx4 v4, s[40:43], s3 offen lds
    s_add_u32 m0, s15, 32768
    s_add_u32 s3, s6, 128
    buffer_load_dwordx4 v3, s[36:39], s3 offen lds
    s_add_u32 m0, s15, 49152
    s_add_u32 s3, s7, 229376
    buffer_load_dwordx4 v4, s[40:43], s3 offen lds
    s_add_u32 m0, s15, 36864
    s_add_u32 s3, s6, 32896
    buffer_load_dwordx4 v3, s[36:39], s3 offen lds
    s_add_u32 m0, s15, 53248
    s_add_u32 s3, s7, 286720
    buffer_load_dwordx4 v4, s[40:43], s3 offen lds
    s_add_u32 m0, s15, 40960
    s_add_u32 s3, s6, 65664
    buffer_load_dwordx4 v3, s[36:39], s3 offen lds
    s_add_u32 m0, s15, 57344
    s_add_u32 s3, s7, 344064
    buffer_load_dwordx4 v4, s[40:43], s3 offen lds
    s_add_u32 m0, s15, 45056
    s_add_u32 s3, s6, 98432
    buffer_load_dwordx4 v3, s[36:39], s3 offen lds
    s_add_u32 m0, s15, 61440
    s_add_u32 s3, s7, 401408
    buffer_load_dwordx4 v4, s[40:43], s3 offen lds
    s_add_u32 m0, s15, 131072
    s_nop 0
    buffer_load_dwordx4 v5, s[44:47], s12 offen lds
    s_add_u32 m0, s15, 135168
    s_add_u32 s3, s12, 4096
    buffer_load_dwordx4 v5, s[44:47], s3 offen lds
    s_add_u32 m0, s15, 139264
    s_add_u32 s3, s12, 8192
    buffer_load_dwordx4 v5, s[44:47], s3 offen lds
    s_add_u32 m0, s15, 143360
    s_add_u32 s3, s12, 12288
    buffer_load_dwordx4 v5, s[44:47], s3 offen lds
    s_add_u32 m0, s15, 147456
    s_nop 0
    buffer_load_dwordx4 v6, s[44:47], s13 offen lds
    s_waitcnt vmcnt(13)
    s_barrier
    s_add_u32 m0, s15, 65536
    s_add_u32 s3, s6, 256
    buffer_load_dwordx4 v3, s[36:39], s3 offen lds
    s_add_u32 m0, s15, 81920
    s_add_u32 s3, s7, 458752
    buffer_load_dwordx4 v4, s[40:43], s3 offen lds
    s_add_u32 m0, s15, 69632
    s_add_u32 s3, s6, 33024
    buffer_load_dwordx4 v3, s[36:39], s3 offen lds
    s_add_u32 m0, s15, 86016
    s_add_u32 s3, s7, 516096
    buffer_load_dwordx4 v4, s[40:43], s3 offen lds
    s_add_u32 m0, s15, 73728
    s_add_u32 s3, s6, 65792
    buffer_load_dwordx4 v3, s[36:39], s3 offen lds
    s_add_u32 m0, s15, 90112
    s_add_u32 s3, s7, 573440
    buffer_load_dwordx4 v4, s[40:43], s3 offen lds
    s_add_u32 m0, s15, 77824
    s_add_u32 s3, s6, 98560
    buffer_load_dwordx4 v3, s[36:39], s3 offen lds
    s_add_u32 m0, s15, 94208
    s_add_u32 s3, s7, 630784
    buffer_load_dwordx4 v4, s[40:43], s3 offen lds
    s_waitcnt vmcnt(8)
    s_barrier
    s_add_u32 m0, s15, 98304
    s_add_u32 s3, s6, 384
    buffer_load_dwordx4 v3, s[36:39], s3 offen lds
    s_add_u32 m0, s15, 114688
    s_add_u32 s3, s7, 688128
    buffer_load_dwordx4 v4, s[40:43], s3 offen lds
    s_add_u32 m0, s15, 102400
    s_add_u32 s3, s6, 33152
    buffer_load_dwordx4 v3, s[36:39], s3 offen lds
    s_add_u32 m0, s15, 118784
    s_add_u32 s3, s7, 745472
    buffer_load_dwordx4 v4, s[40:43], s3 offen lds
    s_add_u32 m0, s15, 106496
    s_add_u32 s3, s6, 65920
    buffer_load_dwordx4 v3, s[36:39], s3 offen lds
    s_add_u32 m0, s15, 122880
    s_add_u32 s3, s7, 802816
    buffer_load_dwordx4 v4, s[40:43], s3 offen lds
    s_add_u32 m0, s15, 110592
    s_add_u32 s3, s6, 98688
    buffer_load_dwordx4 v3, s[36:39], s3 offen lds
    s_add_u32 m0, s15, 126976
    s_add_u32 s3, s7, 860160
    buffer_load_dwordx4 v4, s[40:43], s3 offen lds
    s_waitcnt vmcnt(8)
    s_barrier
    s_add_u32 m0, s15, 0
    s_add_u32 s3, s6, 512
    buffer_load_dwordx4 v3, s[36:39], s3 offen lds
    s_add_u32 m0, s15, 16384
    s_add_u32 s3, s7, 917504
    buffer_load_dwordx4 v4, s[40:43], s3 offen lds
    s_add_u32 m0, s15, 4096
    s_add_u32 s3, s6, 33280
    buffer_load_dwordx4 v3, s[36:39], s3 offen lds
    s_add_u32 m0, s15, 20480
    s_add_u32 s3, s7, 974848
    buffer_load_dwordx4 v4, s[40:43], s3 offen lds
    s_add_u32 m0, s15, 8192
    s_add_u32 s3, s6, 66048
    buffer_load_dwordx4 v3, s[36:39], s3 offen lds
    s_add_u32 m0, s15, 24576
    s_add_u32 s3, s7, 1032192
    buffer_load_dwordx4 v4, s[40:43], s3 offen lds
    s_add_u32 m0, s15, 12288
    s_add_u32 s3, s6, 98816
    buffer_load_dwordx4 v3, s[36:39], s3 offen lds
    s_add_u32 m0, s15, 28672
    s_add_u32 s3, s7, 1089536
    buffer_load_dwordx4 v4, s[40:43], s3 offen lds
    s_waitcnt vmcnt(8)
    s_barrier
    s_add_u32 m0, s15, 32768
    s_add_u32 s3, s6, 640
    buffer_load_dwordx4 v3, s[36:39], s3 offen lds
    s_add_u32 m0, s15, 49152
    s_add_u32 s3, s7, 1146880
    buffer_load_dwordx4 v4, s[40:43], s3 offen lds
    s_add_u32 m0, s15, 36864
    s_add_u32 s3, s6, 33408
    buffer_load_dwordx4 v3, s[36:39], s3 offen lds
    s_add_u32 m0, s15, 53248
    s_add_u32 s3, s7, 1204224
    buffer_load_dwordx4 v4, s[40:43], s3 offen lds
    s_add_u32 m0, s15, 40960
    s_add_u32 s3, s6, 66176
    buffer_load_dwordx4 v3, s[36:39], s3 offen lds
    s_add_u32 m0, s15, 57344
    s_add_u32 s3, s7, 1261568
    buffer_load_dwordx4 v4, s[40:43], s3 offen lds
    s_add_u32 m0, s15, 45056
    s_add_u32 s3, s6, 98944
    buffer_load_dwordx4 v3, s[36:39], s3 offen lds
    s_add_u32 m0, s15, 61440
    s_add_u32 s3, s7, 1318912
    buffer_load_dwordx4 v4, s[40:43], s3 offen lds
    s_waitcnt vmcnt(8)
    s_barrier
    s_add_u32 m0, s15, 65536
    s_add_u32 s3, s6, 768
    buffer_load_dwordx4 v3, s[36:39], s3 offen lds
    s_add_u32 m0, s15, 81920
    s_add_u32 s3, s7, 1376256
    buffer_load_dwordx4 v4, s[40:43], s3 offen lds
    s_add_u32 m0, s15, 69632
    s_add_u32 s3, s6, 33536
    buffer_load_dwordx4 v3, s[36:39], s3 offen lds
    s_add_u32 m0, s15, 86016
    s_add_u32 s3, s7, 1433600
    buffer_load_dwordx4 v4, s[40:43], s3 offen lds
    s_add_u32 m0, s15, 73728
    s_add_u32 s3, s6, 66304
    buffer_load_dwordx4 v3, s[36:39], s3 offen lds
    s_add_u32 m0, s15, 90112
    s_add_u32 s3, s7, 1490944
    buffer_load_dwordx4 v4, s[40:43], s3 offen lds
    s_add_u32 m0, s15, 77824
    s_add_u32 s3, s6, 99072
    buffer_load_dwordx4 v3, s[36:39], s3 offen lds
    s_add_u32 m0, s15, 94208
    s_add_u32 s3, s7, 1548288
    buffer_load_dwordx4 v4, s[40:43], s3 offen lds
    s_waitcnt vmcnt(8)
    s_barrier
    s_add_u32 m0, s15, 98304
    s_add_u32 s3, s6, 896
    buffer_load_dwordx4 v3, s[36:39], s3 offen lds
    s_add_u32 m0, s15, 114688
    s_add_u32 s3, s7, 1605632
    buffer_load_dwordx4 v4, s[40:43], s3 offen lds
    s_add_u32 m0, s15, 102400
    s_add_u32 s3, s6, 33664
    buffer_load_dwordx4 v3, s[36:39], s3 offen lds
    s_add_u32 m0, s15, 118784
    s_add_u32 s3, s7, 1662976
    buffer_load_dwordx4 v4, s[40:43], s3 offen lds
    s_add_u32 m0, s15, 106496
    s_add_u32 s3, s6, 66432
    buffer_load_dwordx4 v3, s[36:39], s3 offen lds
    s_add_u32 m0, s15, 122880
    s_add_u32 s3, s7, 1720320
    buffer_load_dwordx4 v4, s[40:43], s3 offen lds
    s_add_u32 m0, s15, 110592
    s_add_u32 s3, s6, 99200
    buffer_load_dwordx4 v3, s[36:39], s3 offen lds
    s_add_u32 m0, s15, 126976
    s_add_u32 s3, s7, 1777664
    buffer_load_dwordx4 v4, s[40:43], s3 offen lds
    s_waitcnt vmcnt(8)
    s_barrier
    s_waitcnt vmcnt(0)
    s_barrier
    s_endpgm
K5_C:
    s_sub_u32 s8, s8, 4
    s_and_b32 s4, s2, 7
    s_lshl_b32 s4, s4, 1
    s_lshr_b32 s5, s2, 3
    s_cmp_ge_u32 s5, 14
    s_cselect_b32 s3, 1, 0
    s_add_u32 s4, s4, s3
    s_mul_i32 s3, s3, 14
    s_sub_u32 s5, s5, s3
    s_mov_b32 s20, 0x3f803f80
    s_mov_b32 s21, 0x3b000000
    s_mov_b32 s22, 0x3727c5ac
    s_mov_b32 s23, 0xffff0000
    s_mov_b32 s24, 0xc0135761
    s_mov_b32 s25, 0xbdd2d3e8
    s_lshr_b32 s9, s8, 1
    s_and_b32 s10, s8, 1
    s_lshr_b32 s3, s9, 1
    s_lshl_b32 s3, s3, 13
    s_and_b32 s12, s9, 1
    s_lshl_b32 s12, s12, 8
    s_add_u32 s3, s3, s12
    s_add_u32 s3, s3, 131072
    v_lshlrev_b32 v8, 3, v9
    v_lshl_add_u32 v8, v10, 11, v8
    v_add_u32 v8, s3, v8
    s_lshl_b32 s3, s10, 8
    s_add_u32 s3, s3, 147456
    v_and_b32 v11, 7, v9
    v_lshlrev_b32 v11, 9, v11
    v_lshl_add_u32 v11, v10, 4, v11
    v_add_u32 v11, s3, v11
    v_lshrrev_b32 v5, 2, v9
    v_lshlrev_b32 v6, 1, v5
    v_and_b32 v1, 1, v10
    v_lshl_or_b32 v6, v1, 3, v6
    v_lshl_add_u32 v5, v10, 3, v5
    v_lshlrev_b32 v5, 8, v5
    v_and_b32 v1, 1, v9
    v_lshl_add_u32 v5, v1, 3, v5
    v_add_u32 v5, 0x4000, v5
    v_bfe_u32 v1, v9, 1, 1
    s_lshl_b32 s3, s10, 3
    v_add_u32 v1, s3, v1
    v_add_u32 v144, 0, v1
    v_xor_b32 v144, v144, v6
    v_lshl_add_u32 v144, v144, 4, v5
    v_add_u32 v148, 0x10000, v144
    v_add_u32 v145, 2, v1
    v_xor_b32 v145, v145, v6
    v_lshl_add_u32 v145, v145, 4, v5
    v_add_u32 v149, 0x10000, v145
    v_add_u32 v146, 4, v1
    v_xor_b32 v146, v146, v6
    v_lshl_add_u32 v146, v146, 4, v5
    v_add_u32 v150, 0x10000, v146
    v_add_u32 v147, 6, v1
    v_xor_b32 v147, v147, v6
    v_lshl_add_u32 v147, v147, 4, v5
    v_add_u32 v151, 0x10000, v147
    v_and_b32 v5, 7, v9
    v_xor_b32 v5, v10, v5
    v_lshlrev_b32 v5, 4, v5
    s_lshl_b32 s3, s9, 12
    v_lshl_add_u32 v152, v9, 7, v5
    v_add_u32 v152, s3, v152
    v_xor_b32 v153, 64, v152
    v_add_u32 v154, 0x10000, v152
    v_add_u32 v155, 0x10000, v153
    s_mov_b32 s26, s25
    s_mov_b32 s27, s25
    v_mov_b32 v30, s24
    v_mov_b32 v31, s24
    v_mov_b32 v48, 0
    v_mov_b32 v49, 0
    v_mov_b32 v50, 0
    v_mov_b32 v51, 0
    v_mov_b32 v52, 0
    v_mov_b32 v53, 0
    v_mov_b32 v54, 0
    v_mov_b32 v55, 0
    v_mov_b32 v56, 0
    v_mov_b32 v57, 0
    v_mov_b32 v58, 0
    v_mov_b32 v59, 0
    v_mov_b32 v60, 0
    v_mov_b32 v61, 0
    v_mov_b32 v62, 0
    v_mov_b32 v63, 0
    v_mov_b32 v64, 0
    v_mov_b32 v65, 0
    v_mov_b32 v66, 0
    v_mov_b32 v67, 0
    v_mov_b32 v68, 0
    v_mov_b32 v69, 0
    v_mov_b32 v70, 0
    v_mov_b32 v71, 0
    v_mov_b32 v72, 0
    v_mov_b32 v73, 0
    v_mov_b32 v74, 0
    v_mov_b32 v75, 0
    v_mov_b32 v76, 0
    v_mov_b32 v77, 0
    v_mov_b32 v78, 0
    v_mov_b32 v79, 0
    s_barrier
    ds_read_b128 v[32:35], v152 offset:0
    ds_read_b128 v[36:39], v152 offset:2048
    ds_read_b64_tr_b16 v[80:81], v144 offset:0
    ds_read_b64_tr_b16 v[82:83], v144 offset:1024
    ds_read_b64_tr_b16 v[84:85], v145 offset:0
    ds_read_b64_tr_b16 v[86:87], v145 offset:1024
    ds_read_b64_tr_b16 v[88:89], v146 offset:0
    ds_read_b64_tr_b16 v[90:91], v146 offset:1024
    ds_read_b64_tr_b16 v[92:93], v147 offset:0
    ds_read_b64_tr_b16 v[94:95], v147 offset:1024
    ds_read_b128 v[40:43], v153 offset:0
    ds_read_b128 v[44:47], v153 offset:2048
    ds_read_b64_tr_b16 v[96:97], v144 offset:8192
    ds_read_b64_tr_b16 v[98:99], v144 offset:9216
    ds_read_b64_tr_b16 v[100:101], v145 offset:8192
    ds_read_b64_tr_b16 v[102:103], v145 offset:9216
    ds_read_b64_tr_b16 v[104:105], v146 offset:8192
    ds_read_b64_tr_b16 v[106:107], v146 offset:9216
    ds_read_b64_tr_b16 v[108:109], v147 offset:8192
    ds_read_b64_tr_b16 v[110:111], v147 offset:9216
    s_waitcnt lgkmcnt(10)
    v_mfma_f32_16x16x32_bf16 v[48:51], v[80:83], v[32:35], v[48:51]
    v_mfma_f32_16x16x32_bf16 v[64:67], v[80:83], v[36:39], v[64:67]
    v_mfma_f32_16x16x32_bf16 v[52:55], v[84:87], v[32:35], v[52:55]
    v_mfma_f32_16x16x32_bf16 v[68:71], v[84:87], v[36:39], v[68:71]
    v_mfma_f32_16x16x32_bf16 v[56:59], v[88:91], v[32:35], v[56:59]
    v_mfma_f32_16x16x32_bf16 v[72:75], v[88:91], v[36:39], v[72:75]
    v_mfma_f32_16x16x32_bf16 v[60:63], v[92:95], v[32:35], v[60:63]
    v_mfma_f32_16x16x32_bf16 v[76:79], v[92:95], v[36:39], v[76:79]
    s_barrier
    ds_read_b128 v[32:35], v152 offset:32768
    ds_read_b128 v[36:39], v152 offset:34816
    ds_read_b64_tr_b16 v[80:81], v144 offset:32768
    ds_read_b64_tr_b16 v[82:83], v144 offset:33792
    ds_read_b64_tr_b16 v[84:85], v145 offset:32768
    ds_read_b64_tr_b16 v[86:87], v145 offset:33792
    ds_read_b64_tr_b16 v[88:89], v146 offset:32768
    ds_read_b64_tr_b16 v[90:91], v146 offset:33792
    ds_read_b64_tr_b16 v[92:93], v147 offset:32768
    ds_read_b64_tr_b16 v[94:95], v147 offset:33792
    s_waitcnt lgkmcnt(10)
    v_mfma_f32_16x16x32_bf16 v[48:51], v[96:99], v[40:43], v[48:51]
    v_mfma_f32_16x16x32_bf16 v[64:67], v[96:99], v[44:47], v[64:67]
    v_mfma_f32_16x16x32_bf16 v[52:55], v[100:103], v[40:43], v[52:55]
    v_mfma_f32_16x16x32_bf16 v[68:71], v[100:103], v[44:47], v[68:71]
    v_mfma_f32_16x16x32_bf16 v[56:59], v[104:107], v[40:43], v[56:59]
    v_mfma_f32_16x16x32_bf16 v[72:75], v[104:107], v[44:47], v[72:75]
    v_mfma_f32_16x16x32_bf16 v[60:63], v[108:111], v[40:43], v[60:63]
    v_mfma_f32_16x16x32_bf16 v[76:79], v[108:111], v[44:47], v[76:79]
    ds_read_b64 v[128:129], v8 offset:0
    ds_read_b64 v[130:131], v8 offset:512
    ds_read_b64 v[132:133], v8 offset:1024
    ds_read_b64 v[134:135], v8 offset:1536
    ds_read_b64 v[136:137], v8 offset:128
    ds_read_b64 v[138:139], v8 offset:640
    ds_read_b64 v[140:141], v8 offset:1152
    ds_read_b64 v[142:143], v8 offset:1664
    ds_read_b128 v[112:115], v11 offset:0
    ds_read_b128 v[116:119], v11 offset:64
    ds_read_b128 v[120:123], v11 offset:128
    ds_read_b128 v[124:127], v11 offset:192
    ds_read_b128 v[40:43], v153 offset:32768
    ds_read_b128 v[44:47], v153 offset:34816
    ds_read_b64_tr_b16 v[96:97], v144 offset:40960
    ds_read_b64_tr_b16 v[98:99], v144 offset:41984
    ds_read_b64_tr_b16 v[100:101], v145 offset:40960
    ds_read_b64_tr_b16 v[102:103], v145 offset:41984
    ds_read_b64_tr_b16 v[104:105], v146 offset:40960
    ds_read_b64_tr_b16 v[106:107], v146 offset:41984
    ds_read_b64_tr_b16 v[108:109], v147 offset:40960
    ds_read_b64_tr_b16 v[110:111], v147 offset:41984
    s_waitcnt lgkmcnt(15)
    v_mfma_f32_16x16x32_bf16 v[48:51], v[80:83], v[32:35], v[48:51]
    v_mfma_f32_16x16x32_bf16 v[64:67], v[80:83], v[36:39], v[64:67]
    v_mfma_f32_16x16x32_bf16 v[52:55], v[84:87], v[32:35], v[52:55]
    v_mfma_f32_16x16x32_bf16 v[68:71], v[84:87], v[36:39], v[68:71]
    v_mfma_f32_16x16x32_bf16 v[56:59], v[88:91], v[32:35], v[56:59]
    v_mfma_f32_16x16x32_bf16 v[72:75], v[88:91], v[36:39], v[72:75]
    v_mfma_f32_16x16x32_bf16 v[60:63], v[92:95], v[32:35], v[60:63]
    v_mfma_f32_16x16x32_bf16 v[76:79], v[92:95], v[36:39], v[76:79]
    s_barrier
    ds_read_b128 v[32:35], v154 offset:0
    ds_read_b128 v[36:39], v154 offset:2048
    ds_read_b64_tr_b16 v[80:81], v148 offset:0
    ds_read_b64_tr_b16 v[82:83], v148 offset:1024
    ds_read_b64_tr_b16 v[84:85], v149 offset:0
    ds_read_b64_tr_b16 v[86:87], v149 offset:1024
    ds_read_b64_tr_b16 v[88:89], v150 offset:0
    ds_read_b64_tr_b16 v[90:91], v150 offset:1024
    ds_read_b64_tr_b16 v[92:93], v151 offset:0
    ds_read_b64_tr_b16 v[94:95], v151 offset:1024
    s_waitcnt lgkmcnt(10)
    v_mfma_f32_16x16x32_bf16 v[48:51], v[96:99], v[40:43], v[48:51]
    v_mfma_f32_16x16x32_bf16 v[64:67], v[96:99], v[44:47], v[64:67]
    v_mfma_f32_16x16x32_bf16 v[52:55], v[100:103], v[40:43], v[52:55]
    v_mfma_f32_16x16x32_bf16 v[68:71], v[100:103], v[44:47], v[68:71]
    v_mfma_f32_16x16x32_bf16 v[56:59], v[104:107], v[40:43], v[56:59]
    v_mfma_f32_16x16x32_bf16 v[72:75], v[104:107], v[44:47], v[72:75]
    v_mfma_f32_16x16x32_bf16 v[60:63], v[108:111], v[40:43], v[60:63]
    v_mfma_f32_16x16x32_bf16 v[76:79], v[108:111], v[44:47], v[76:79]
    ds_read_b128 v[40:43], v155 offset:0
    ds_read_b128 v[44:47], v155 offset:2048
    ds_read_b64_tr_b16 v[96:97], v148 offset:8192
    ds_read_b64_tr_b16 v[98:99], v148 offset:9216
    ds_read_b64_tr_b16 v[100:101], v149 offset:8192
    ds_read_b64_tr_b16 v[102:103], v149 offset:9216
    ds_read_b64_tr_b16 v[104:105], v150 offset:8192
    ds_read_b64_tr_b16 v[106:107], v150 offset:9216
    ds_read_b64_tr_b16 v[108:109], v151 offset:8192
    ds_read_b64_tr_b16 v[110:111], v151 offset:9216
    s_waitcnt lgkmcnt(10)
    v_mfma_f32_16x16x32_bf16 v[48:51], v[80:83], v[32:35], v[48:51]
    v_mfma_f32_16x16x32_bf16 v[64:67], v[80:83], v[36:39], v[64:67]
    v_mfma_f32_16x16x32_bf16 v[52:55], v[84:87], v[32:35], v[52:55]
    v_mfma_f32_16x16x32_bf16 v[68:71], v[84:87], v[36:39], v[68:71]
    v_mfma_f32_16x16x32_bf16 v[56:59], v[88:91], v[32:35], v[56:59]
    v_mfma_f32_16x16x32_bf16 v[72:75], v[88:91], v[36:39], v[72:75]
    v_mfma_f32_16x16x32_bf16 v[60:63], v[92:95], v[32:35], v[60:63]
    v_mfma_f32_16x16x32_bf16 v[76:79], v[92:95], v[36:39], v[76:79]
    s_barrier
    ds_read_b128 v[32:35], v154 offset:32768
    ds_read_b128 v[36:39], v154 offset:34816
    ds_read_b64_tr_b16 v[80:81], v148 offset:32768
    ds_read_b64_tr_b16 v[82:83], v148 offset:33792
    ds_read_b64_tr_b16 v[84:85], v149 offset:32768
    ds_read_b64_tr_b16 v[86:87], v149 offset:33792
    ds_read_b64_tr_b16 v[88:89], v150 offset:32768
    ds_read_b64_tr_b16 v[90:91], v150 offset:33792
    ds_read_b64_tr_b16 v[92:93], v151 offset:32768
    ds_read_b64_tr_b16 v[94:95], v151 offset:33792
    s_waitcnt lgkmcnt(10)
    v_mfma_f32_16x16x32_bf16 v[48:51], v[96:99], v[40:43], v[48:51]
    v_mfma_f32_16x16x32_bf16 v[64:67], v[96:99], v[44:47], v[64:67]
    v_mfma_f32_16x16x32_bf16 v[52:55], v[100:103], v[40:43], v[52:55]
    v_mfma_f32_16x16x32_bf16 v[68:71], v[100:103], v[44:47], v[68:71]
    v_mfma_f32_16x16x32_bf16 v[56:59], v[104:107], v[40:43], v[56:59]
    v_mfma_f32_16x16x32_bf16 v[72:75], v[104:107], v[44:47], v[72:75]
    v_mfma_f32_16x16x32_bf16 v[60:63], v[108:111], v[40:43], v[60:63]
    v_mfma_f32_16x16x32_bf16 v[76:79], v[108:111], v[44:47], v[76:79]
    v_add_f32 v128, v128, v130
    v_add_f32 v129, v129, v131
    v_add_f32 v132, v132, v134
    v_add_f32 v133, v133, v135
    v_add_f32 v128, v128, v132
    v_add_f32 v129, v129, v133
    v_mov_b32 v130, v128
    s_nop 1
    v_permlane32_swap_b32 v128, v130
    v_add_f32 v128, v128, v130
    v_mov_b32 v130, v128
    s_nop 1
    v_permlane16_swap_b32 v128, v130
    v_add_f32 v128, v128, v130
    v_mov_b32 v130, v129
    s_nop 1
    v_permlane32_swap_b32 v129, v130
    v_add_f32 v129, v129, v130
    v_mov_b32 v130, v129
    s_nop 1
    v_permlane16_swap_b32 v129, v130
    v_add_f32 v129, v129, v130
    v_mul_f32 v128, s21, v128
    v_mul_f32 v130, s21, v129
    v_fma_f32 v130, -v128, v128, v130
    v_max_f32 v130, 0, v130
    v_cvt_pk_bf16_f32 v130, v130, v130
    v_lshlrev_b32 v130, 16, v130
    v_add_f32 v130, s22, v130
    v_cvt_pk_bf16_f32 v130, v130, v130
    v_lshlrev_b32 v130, 16, v130
    v_sqrt_f32 v130, v130
    s_nop 0
    v_cvt_pk_bf16_f32 v130, v130, v130
    v_lshlrev_b32 v130, 16, v130
    v_cvt_pk_bf16_f32 v128, v128, v128
    v_lshlrev_b32 v128, 16, v128
    v_rcp_f32 v130, v130
    v_sub_f32 v128, 0, v128
    v_mov_b32 v129, v128
    v_mov_b32 v131, v130
    ds_read_b128 v[40:43], v155 offset:32768
    ds_read_b128 v[44:47], v155 offset:34816
    ds_read_b64_tr_b16 v[96:97], v148 offset:40960
    ds_read_b64_tr_b16 v[98:99], v148 offset:41984
    ds_read_b64_tr_b16 v[100:101], v149 offset:40960
    ds_read_b64_tr_b16 v[102:103], v149 offset:41984
    ds_read_b64_tr_b16 v[104:105], v150 offset:40960
    ds_read_b64_tr_b16 v[106:107], v150 offset:41984
    ds_read_b64_tr_b16 v[108:109], v151 offset:40960
    ds_read_b64_tr_b16 v[110:111], v151 offset:41984
    s_waitcnt lgkmcnt(10)
    v_mfma_f32_16x16x32_bf16 v[48:51], v[80:83], v[32:35], v[48:51]
    v_mfma_f32_16x16x32_bf16 v[64:67], v[80:83], v[36:39], v[64:67]
    v_mfma_f32_16x16x32_bf16 v[52:55], v[84:87], v[32:35], v[52:55]
    v_mfma_f32_16x16x32_bf16 v[68:71], v[84:87], v[36:39], v[68:71]
    v_mfma_f32_16x16x32_bf16 v[56:59], v[88:91], v[32:35], v[56:59]
    v_mfma_f32_16x16x32_bf16 v[72:75], v[88:91], v[36:39], v[72:75]
    v_mfma_f32_16x16x32_bf16 v[60:63], v[92:95], v[32:35], v[60:63]
    v_mfma_f32_16x16x32_bf16 v[76:79], v[92:95], v[36:39], v[76:79]
    s_barrier
    ds_read_b128 v[32:35], v152 offset:0
    ds_read_b128 v[36:39], v152 offset:2048
    ds_read_b64_tr_b16 v[80:81], v144 offset:0
    ds_read_b64_tr_b16 v[82:83], v144 offset:1024
    ds_read_b64_tr_b16 v[84:85], v145 offset:0
    ds_read_b64_tr_b16 v[86:87], v145 offset:1024
    ds_read_b64_tr_b16 v[88:89], v146 offset:0
    ds_read_b64_tr_b16 v[90:91], v146 offset:1024
    ds_read_b64_tr_b16 v[92:93], v147 offset:0
    ds_read_b64_tr_b16 v[94:95], v147 offset:1024
    s_waitcnt lgkmcnt(10)
    v_mfma_f32_16x16x32_bf16 v[48:51], v[96:99], v[40:43], v[48:51]
    v_mfma_f32_16x16x32_bf16 v[64:67], v[96:99], v[44:47], v[64:67]
    v_mfma_f32_16x16x32_bf16 v[52:55], v[100:103], v[40:43], v[52:55]
    v_mfma_f32_16x16x32_bf16 v[68:71], v[100:103], v[44:47], v[68:71]
    v_mfma_f32_16x16x32_bf16 v[56:59], v[104:107], v[40:43], v[56:59]
    v_mfma_f32_16x16x32_bf16 v[72:75], v[104:107], v[44:47], v[72:75]
    v_mfma_f32_16x16x32_bf16 v[60:63], v[108:111], v[40:43], v[60:63]
    v_mfma_f32_16x16x32_bf16 v[76:79], v[108:111], v[44:47], v[76:79]
    v_add_f32 v136, v136, v138
    v_add_f32 v137, v137, v139
    v_add_f32 v140, v140, v142
    v_add_f32 v141, v141, v143
    v_add_f32 v136, v136, v140
    v_add_f32 v137, v137, v141
    v_mov_b32 v138, v136
    s_nop 1
    v_permlane32_swap_b32 v136, v138
    v_add_f32 v136, v136, v138
    v_mov_b32 v138, v136
    s_nop 1
    v_permlane16_swap_b32 v136, v138
    v_add_f32 v136, v136, v138
    v_mov_b32 v138, v137
    s_nop 1
    v_permlane32_swap_b32 v137, v138
    v_add_f32 v137, v137, v138
    v_mov_b32 v138, v137
    s_nop 1
    v_permlane16_swap_b32 v137, v138
    v_add_f32 v137, v137, v138
    v_mul_f32 v136, s21, v136
    v_mul_f32 v138, s21, v137
    v_fma_f32 v138, -v136, v136, v138
    v_max_f32 v138, 0, v138
    v_cvt_pk_bf16_f32 v138, v138, v138
    v_lshlrev_b32 v138, 16, v138
    v_add_f32 v138, s22, v138
    v_cvt_pk_bf16_f32 v138, v138, v138
    v_lshlrev_b32 v138, 16, v138
    v_sqrt_f32 v138, v138
    s_nop 0
    v_cvt_pk_bf16_f32 v138, v138, v138
    v_lshlrev_b32 v138, 16, v138
    v_cvt_pk_bf16_f32 v136, v136, v136
    v_lshlrev_b32 v136, 16, v136
    v_rcp_f32 v138, v138
    v_sub_f32 v136, 0, v136
    v_mov_b32 v137, v136
    v_mov_b32 v139, v138
    ds_read_b128 v[40:43], v153 offset:0
    ds_read_b128 v[44:47], v153 offset:2048
    ds_read_b64_tr_b16 v[96:97], v144 offset:8192
    ds_read_b64_tr_b16 v[98:99], v144 offset:9216
    ds_read_b64_tr_b16 v[100:101], v145 offset:8192
    ds_read_b64_tr_b16 v[102:103], v145 offset:9216
    ds_read_b64_tr_b16 v[104:105], v146 offset:8192
    ds_read_b64_tr_b16 v[106:107], v146 offset:9216
    ds_read_b64_tr_b16 v[108:109], v147 offset:8192
    ds_read_b64_tr_b16 v[110:111], v147 offset:9216
    s_waitcnt lgkmcnt(10)
    v_mfma_f32_16x16x32_bf16 v[48:51], v[80:83], v[32:35], v[48:51]
    v_mfma_f32_16x16x32_bf16 v[64:67], v[80:83], v[36:39], v[64:67]
    v_mfma_f32_16x16x32_bf16 v[52:55], v[84:87], v[32:35], v[52:55]
    v_mfma_f32_16x16x32_bf16 v[68:71], v[84:87], v[36:39], v[68:71]
    v_mfma_f32_16x16x32_bf16 v[56:59], v[88:91], v[32:35], v[56:59]
    v_mfma_f32_16x16x32_bf16 v[72:75], v[88:91], v[36:39], v[72:75]
    v_mfma_f32_16x16x32_bf16 v[60:63], v[92:95], v[32:35], v[60:63]
    v_mfma_f32_16x16x32_bf16 v[76:79], v[92:95], v[36:39], v[76:79]
    s_barrier
    ds_read_b128 v[32:35], v152 offset:32768
    ds_read_b128 v[36:39], v152 offset:34816
    ds_read_b64_tr_b16 v[80:81], v144 offset:32768
    ds_read_b64_tr_b16 v[82:83], v144 offset:33792
    ds_read_b64_tr_b16 v[84:85], v145 offset:32768
    ds_read_b64_tr_b16 v[86:87], v145 offset:33792
    ds_read_b64_tr_b16 v[88:89], v146 offset:32768
    ds_read_b64_tr_b16 v[90:91], v146 offset:33792
    ds_read_b64_tr_b16 v[92:93], v147 offset:32768
    ds_read_b64_tr_b16 v[94:95], v147 offset:33792
    s_waitcnt lgkmcnt(10)
    v_mfma_f32_16x16x32_bf16 v[48:51], v[96:99], v[40:43], v[48:51]
    v_mfma_f32_16x16x32_bf16 v[64:67], v[96:99], v[44:47], v[64:67]
    v_mfma_f32_16x16x32_bf16 v[52:55], v[100:103], v[40:43], v[52:55]
    v_mfma_f32_16x16x32_bf16 v[68:71], v[100:103], v[44:47], v[68:71]
    v_mfma_f32_16x16x32_bf16 v[56:59], v[104:107], v[40:43], v[56:59]
    v_mfma_f32_16x16x32_bf16 v[72:75], v[104:107], v[44:47], v[72:75]
    v_mfma_f32_16x16x32_bf16 v[60:63], v[108:111], v[40:43], v[60:63]
    v_mfma_f32_16x16x32_bf16 v[76:79], v[108:111], v[44:47], v[76:79]
    v_add_f32_dpp v112, v112, v112 quad_perm:[1,0,3,2] row_mask:0xf bank_mask:0xf
    v_add_f32_dpp v113, v113, v113 quad_perm:[1,0,3,2] row_mask:0xf bank_mask:0xf
    v_add_f32_dpp v114, v114, v114 quad_perm:[1,0,3,2] row_mask:0xf bank_mask:0xf
    v_add_f32_dpp v115, v115, v115 quad_perm:[1,0,3,2] row_mask:0xf bank_mask:0xf
    v_add_f32_dpp v116, v116, v116 quad_perm:[1,0,3,2] row_mask:0xf bank_mask:0xf
    v_add_f32_dpp v117, v117, v117 quad_perm:[1,0,3,2] row_mask:0xf bank_mask:0xf
    v_add_f32_dpp v118, v118, v118 quad_perm:[1,0,3,2] row_mask:0xf bank_mask:0xf
    v_add_f32_dpp v119, v119, v119 quad_perm:[1,0,3,2] row_mask:0xf bank_mask:0xf
    v_add_f32_dpp v120, v120, v120 quad_perm:[1,0,3,2] row_mask:0xf bank_mask:0xf
    v_add_f32_dpp v121, v121, v121 quad_perm:[1,0,3,2] row_mask:0xf bank_mask:0xf
    v_add_f32_dpp v122, v122, v122 quad_perm:[1,0,3,2] row_mask:0xf bank_mask:0xf
    v_add_f32_dpp v123, v123, v123 quad_perm:[1,0,3,2] row_mask:0xf bank_mask:0xf
    v_add_f32_dpp v124, v124, v124 quad_perm:[1,0,3,2] row_mask:0xf bank_mask:0xf
    v_add_f32_dpp v125, v125, v125 quad_perm:[1,0,3,2] row_mask:0xf bank_mask:0xf
    v_add_f32_dpp v126, v126, v126 quad_perm:[1,0,3,2] row_mask:0xf bank_mask:0xf
    v_add_f32_dpp v127, v127, v127 quad_perm:[1,0,3,2] row_mask:0xf bank_mask:0xf
    v_add_f32_dpp v112, v112, v112 quad_perm:[2,3,0,1] row_mask:0xf bank_mask:0xf
    v_add_f32_dpp v113, v113, v113 quad_perm:[2,3,0,1] row_mask:0xf bank_mask:0xf
    v_add_f32_dpp v114, v114, v114 quad_perm:[2,3,0,1] row_mask:0xf bank_mask:0xf
    v_add_f32_dpp v115, v115, v115 quad_perm:[2,3,0,1] row_mask:0xf bank_mask:0xf
    v_add_f32_dpp v116, v116, v116 quad_perm:[2,3,0,1] row_mask:0xf bank_mask:0xf
    v_add_f32_dpp v117, v117, v117 quad_perm:[2,3,0,1] row_mask:0xf bank_mask:0xf
    v_add_f32_dpp v118, v118, v118 quad_perm:[2,3,0,1] row_mask:0xf bank_mask:0xf
    v_add_f32_dpp v119, v119, v119 quad_perm:[2,3,0,1] row_mask:0xf bank_mask:0xf
    ds_read_b128 v[40:43], v153 offset:32768
    ds_read_b128 v[44:47], v153 offset:34816
    ds_read_b64_tr_b16 v[96:97], v144 offset:40960
    ds_read_b64_tr_b16 v[98:99], v144 offset:41984
    ds_read_b64_tr_b16 v[100:101], v145 offset:40960
    ds_read_b64_tr_b16 v[102:103], v145 offset:41984
    ds_read_b64_tr_b16 v[104:105], v146 offset:40960
    ds_read_b64_tr_b16 v[106:107], v146 offset:41984
    ds_read_b64_tr_b16 v[108:109], v147 offset:40960
    ds_read_b64_tr_b16 v[110:111], v147 offset:41984
    s_waitcnt lgkmcnt(10)
    v_mfma_f32_16x16x32_bf16 v[48:51], v[80:83], v[32:35], v[48:51]
    v_mfma_f32_16x16x32_bf16 v[64:67], v[80:83], v[36:39], v[64:67]
    v_mfma_f32_16x16x32_bf16 v[52:55], v[84:87], v[32:35], v[52:55]
    v_mfma_f32_16x16x32_bf16 v[68:71], v[84:87], v[36:39], v[68:71]
    v_mfma_f32_16x16x32_bf16 v[56:59], v[88:91], v[32:35], v[56:59]
    v_mfma_f32_16x16x32_bf16 v[72:75], v[88:91], v[36:39], v[72:75]
    v_mfma_f32_16x16x32_bf16 v[60:63], v[92:95], v[32:35], v[60:63]
    v_mfma_f32_16x16x32_bf16 v[76:79], v[92:95], v[36:39], v[76:79]
    s_barrier
    ds_read_b128 v[32:35], v154 offset:0
    ds_read_b128 v[36:39], v154 offset:2048
    ds_read_b64_tr_b16 v[80:81], v148 offset:0
    ds_read_b64_tr_b16 v[82:83], v148 offset:1024
    ds_read_b64_tr_b16 v[84:85], v149 offset:0
    ds_read_b64_tr_b16 v[86:87], v149 offset:1024
    ds_read_b64_tr_b16 v[88:89], v150 offset:0
    ds_read_b64_tr_b16 v[90:91], v150 offset:1024
    ds_read_b64_tr_b16 v[92:93], v151 offset:0
    ds_read_b64_tr_b16 v[94:95], v151 offset:1024
    s_waitcnt lgkmcnt(10)
    v_mfma_f32_16x16x32_bf16 v[48:51], v[96:99], v[40:43], v[48:51]
    v_mfma_f32_16x16x32_bf16 v[64:67], v[96:99], v[44:47], v[64:67]
    v_mfma_f32_16x16x32_bf16 v[52:55], v[100:103], v[40:43], v[52:55]
    v_mfma_f32_16x16x32_bf16 v[68:71], v[100:103], v[44:47], v[68:71]
    v_mfma_f32_16x16x32_bf16 v[56:59], v[104:107], v[40:43], v[56:59]
    v_mfma_f32_16x16x32_bf16 v[72:75], v[104:107], v[44:47], v[72:75]
    v_mfma_f32_16x16x32_bf16 v[60:63], v[108:111], v[40:43], v[60:63]
    v_mfma_f32_16x16x32_bf16 v[76:79], v[108:111], v[44:47], v[76:79]
    v_add_f32_dpp v120, v120, v120 quad_perm:[2,3,0,1] row_mask:0xf bank_mask:0xf
    v_add_f32_dpp v121, v121, v121 quad_perm:[2,3,0,1] row_mask:0xf bank_mask:0xf
    v_add_f32_dpp v122, v122, v122 quad_perm:[2,3,0,1] row_mask:0xf bank_mask:0xf
    v_add_f32_dpp v123, v123, v123 quad_perm:[2,3,0,1] row_mask:0xf bank_mask:0xf
    v_add_f32_dpp v124, v124, v124 quad_perm:[2,3,0,1] row_mask:0xf bank_mask:0xf
    v_add_f32_dpp v125, v125, v125 quad_perm:[2,3,0,1] row_mask:0xf bank_mask:0xf
    v_add_f32_dpp v126, v126, v126 quad_perm:[2,3,0,1] row_mask:0xf bank_mask:0xf
    v_add_f32_dpp v127, v127, v127 quad_perm:[2,3,0,1] row_mask:0xf bank_mask:0xf
    v_add_f32_dpp v112, v112, v112 row_half_mirror row_mask:0xf bank_mask:0xf
    v_add_f32_dpp v113, v113, v113 row_half_mirror row_mask:0xf bank_mask:0xf
    v_add_f32_dpp v114, v114, v114 row_half_mirror row_mask:0xf bank_mask:0xf
    v_add_f32_dpp v115, v115, v115 row_half_mirror row_mask:0xf bank_mask:0xf
    v_add_f32_dpp v116, v116, v116 row_half_mirror row_mask:0xf bank_mask:0xf
    v_add_f32_dpp v117, v117, v117 row_half_mirror row_mask:0xf bank_mask:0xf
    v_add_f32_dpp v118, v118, v118 row_half_mirror row_mask:0xf bank_mask:0xf
    v_add_f32_dpp v119, v119, v119 row_half_mirror row_mask:0xf bank_mask:0xf
    v_add_f32_dpp v120, v120, v120 row_half_mirror row_mask:0xf bank_mask:0xf
    v_add_f32_dpp v121, v121, v121 row_half_mirror row_mask:0xf bank_mask:0xf
    v_add_f32_dpp v122, v122, v122 row_half_mirror row_mask:0xf bank_mask:0xf
    v_add_f32_dpp v123, v123, v123 row_half_mirror row_mask:0xf bank_mask:0xf
    v_add_f32_dpp v124, v124, v124 row_half_mirror row_mask:0xf bank_mask:0xf
    v_add_f32_dpp v125, v125, v125 row_half_mirror row_mask:0xf bank_mask:0xf
    v_add_f32_dpp v126, v126, v126 row_half_mirror row_mask:0xf bank_mask:0xf
    v_add_f32_dpp v127, v127, v127 row_half_mirror row_mask:0xf bank_mask:0xf
    ds_read_b128 v[40:43], v155 offset:0
    ds_read_b128 v[44:47], v155 offset:2048
    ds_read_b64_tr_b16 v[96:97], v148 offset:8192
    ds_read_b64_tr_b16 v[98:99], v148 offset:9216
    ds_read_b64_tr_b16 v[100:101], v149 offset:8192
    ds_read_b64_tr_b16 v[102:103], v149 offset:9216
    ds_read_b64_tr_b16 v[104:105], v150 offset:8192
    ds_read_b64_tr_b16 v[106:107], v150 offset:9216
    ds_read_b64_tr_b16 v[108:109], v151 offset:8192
    ds_read_b64_tr_b16 v[110:111], v151 offset:9216
    s_waitcnt lgkmcnt(10)
    v_mfma_f32_16x16x32_bf16 v[48:51], v[80:83], v[32:35], v[48:51]
    v_mfma_f32_16x16x32_bf16 v[64:67], v[80:83], v[36:39], v[64:67]
    v_mfma_f32_16x16x32_bf16 v[52:55], v[84:87], v[32:35], v[52:55]
    v_mfma_f32_16x16x32_bf16 v[68:71], v[84:87], v[36:39], v[68:71]
    v_mfma_f32_16x16x32_bf16 v[56:59], v[88:91], v[32:35], v[56:59]
    v_mfma_f32_16x16x32_bf16 v[72:75], v[88:91], v[36:39], v[72:75]
    v_mfma_f32_16x16x32_bf16 v[60:63], v[92:95], v[32:35], v[60:63]
    v_mfma_f32_16x16x32_bf16 v[76:79], v[92:95], v[36:39], v[76:79]
    s_barrier
    ds_read_b128 v[32:35], v154 offset:32768
    ds_read_b128 v[36:39], v154 offset:34816
    ds_read_b64_tr_b16 v[80:81], v148 offset:32768
    ds_read_b64_tr_b16 v[82:83], v148 offset:33792
    ds_read_b64_tr_b16 v[84:85], v149 offset:32768
    ds_read_b64_tr_b16 v[86:87], v149 offset:33792
    ds_read_b64_tr_b16 v[88:89], v150 offset:32768
    ds_read_b64_tr_b16 v[90:91], v150 offset:33792
    ds_read_b64_tr_b16 v[92:93], v151 offset:32768
    ds_read_b64_tr_b16 v[94:95], v151 offset:33792
    s_waitcnt lgkmcnt(10)
    v_mfma_f32_16x16x32_bf16 v[48:51], v[96:99], v[40:43], v[48:51]
    v_mfma_f32_16x16x32_bf16 v[64:67], v[96:99], v[44:47], v[64:67]
    v_mfma_f32_16x16x32_bf16 v[52:55], v[100:103], v[40:43], v[52:55]
    v_mfma_f32_16x16x32_bf16 v[68:71], v[100:103], v[44:47], v[68:71]
    v_mfma_f32_16x16x32_bf16 v[56:59], v[104:107], v[40:43], v[56:59]
    v_mfma_f32_16x16x32_bf16 v[72:75], v[104:107], v[44:47], v[72:75]
    v_mfma_f32_16x16x32_bf16 v[60:63], v[108:111], v[40:43], v[60:63]
    v_mfma_f32_16x16x32_bf16 v[76:79], v[108:111], v[44:47], v[76:79]
    ds_read_b128 v[40:43], v155 offset:32768
    ds_read_b128 v[44:47], v155 offset:34816
    ds_read_b64_tr_b16 v[96:97], v148 offset:40960
    ds_read_b64_tr_b16 v[98:99], v148 offset:41984
    ds_read_b64_tr_b16 v[100:101], v149 offset:40960
    ds_read_b64_tr_b16 v[102:103], v149 offset:41984
    ds_read_b64_tr_b16 v[104:105], v150 offset:40960
    ds_read_b64_tr_b16 v[106:107], v150 offset:41984
    ds_read_b64_tr_b16 v[108:109], v151 offset:40960
    ds_read_b64_tr_b16 v[110:111], v151 offset:41984
    s_waitcnt lgkmcnt(10)
    v_mfma_f32_16x16x32_bf16 v[48:51], v[80:83], v[32:35], v[48:51]
    v_mfma_f32_16x16x32_bf16 v[64:67], v[80:83], v[36:39], v[64:67]
    v_mfma_f32_16x16x32_bf16 v[52:55], v[84:87], v[32:35], v[52:55]
    v_mfma_f32_16x16x32_bf16 v[68:71], v[84:87], v[36:39], v[68:71]
    v_mfma_f32_16x16x32_bf16 v[56:59], v[88:91], v[32:35], v[56:59]
    v_mfma_f32_16x16x32_bf16 v[72:75], v[88:91], v[36:39], v[72:75]
    v_mfma_f32_16x16x32_bf16 v[60:63], v[92:95], v[32:35], v[60:63]
    v_mfma_f32_16x16x32_bf16 v[76:79], v[92:95], v[36:39], v[76:79]
    s_waitcnt lgkmcnt(0)
    v_mfma_f32_16x16x32_bf16 v[48:51], v[96:99], v[40:43], v[48:51]
    v_mfma_f32_16x16x32_bf16 v[64:67], v[96:99], v[44:47], v[64:67]
    v_mfma_f32_16x16x32_bf16 v[52:55], v[100:103], v[40:43], v[52:55]
    v_mfma_f32_16x16x32_bf16 v[68:71], v[100:103], v[44:47], v[68:71]
    v_mfma_f32_16x16x32_bf16 v[56:59], v[104:107], v[40:43], v[56:59]
    v_mfma_f32_16x16x32_bf16 v[72:75], v[104:107], v[44:47], v[72:75]
    v_mfma_f32_16x16x32_bf16 v[60:63], v[108:111], v[40:43], v[60:63]
    v_mfma_f32_16x16x32_bf16 v[76:79], v[108:111], v[44:47], v[76:79]
    s_mul_i32 s3, s8, 4608
    v_mul_u32_u24 v5, 144, v9
    v_lshl_add_u32 v5, v10, 3, v5
    v_add_u32 v5, s3, v5
    v_lshrrev_b32 v6, 3, v2
    v_and_b32 v1, 7, v2
    v_mul_u32_u24 v8, 144, v6
    v_lshl_add_u32 v8, v1, 4, v8
    v_add_u32 v8, s3, v8
    s_lshl_b32 s6, s4, 7
    s_lshl_b32 s7, s9, 5
    s_add_u32 s6, s6, s7
    v_add_u32 v7, s6, v6
    v_mul_u32_u24 v7, 3584, v7
    v_lshl_add_u32 v7, v1, 4, v7
    s_lshl_b32 s7, s5, 8
    s_lshl_b32 s3, s10, 7
    s_add_u32 s7, s7, s3
    v_add_u32 v7, s7, v7
    s_add_u32 s48, s32, 21102592
    s_addc_u32 s49, s33, 0
    v_pk_fma_f32 v[48:49], v[112:113], v[128:129], v[48:49]
    v_pk_fma_f32 v[50:51], v[114:115], v[128:129], v[50:51]
    v_pk_mul_f32 v[48:49], v[48:49], v[130:131]
    v_pk_mul_f32 v[50:51], v[50:51], v[130:131]
    v_cvt_pk_bf16_f32 v96, v48, v49
    v_cvt_pk_bf16_f32 v97, v50, v51
    v_lshlrev_b32 v48, 16, v96
    v_and_b32 v49, s23, v96
    v_lshlrev_b32 v50, 16, v97
    v_and_b32 v51, s23, v97
    v_pk_mul_f32 v[96:97], v[48:49], v[48:49]
    v_pk_mul_f32 v[98:99], v[50:51], v[50:51]
    v_pk_fma_f32 v[96:97], v[96:97], s[26:27], v[30:31]
    v_pk_fma_f32 v[98:99], v[98:99], s[26:27], v[30:31]
    v_pk_mul_f32 v[96:97], v[96:97], v[48:49]
    v_pk_mul_f32 v[98:99], v[98:99], v[50:51]
    v_exp_f32 v96, v96
    v_exp_f32 v97, v97
    v_exp_f32 v98, v98
    v_exp_f32 v99, v99
    v_pk_add_f32 v[96:97], v[96:97], 1.0 op_sel_hi:[1,0]
    v_pk_add_f32 v[98:99], v[98:99], 1.0 op_sel_hi:[1,0]
    v_rcp_f32 v96, v96
    v_rcp_f32 v97, v97
    v_rcp_f32 v98, v98
    v_rcp_f32 v99, v99
    v_pk_mul_f32 v[48:49], v[48:49], v[96:97]
    v_pk_mul_f32 v[50:51], v[50:51], v[98:99]
    v_cvt_pk_bf16_f32 v80, v48, v49
    v_cvt_pk_bf16_f32 v81, v50, v51
    ds_write_b64 v5, v[80:81] offset:0
    v_pk_fma_f32 v[52:53], v[116:117], v[128:129], v[52:53]
    v_pk_fma_f32 v[54:55], v[118:119], v[128:129], v[54:55]
    v_pk_mul_f32 v[52:53], v[52:53], v[130:131]
    v_pk_mul_f32 v[54:55], v[54:55], v[130:131]
    v_cvt_pk_bf16_f32 v104, v52, v53
    v_cvt_pk_bf16_f32 v105, v54, v55
    v_lshlrev_b32 v52, 16, v104
    v_and_b32 v53, s23, v104
    v_lshlrev_b32 v54, 16, v105
    v_and_b32 v55, s23, v105
    v_pk_mul_f32 v[104:105], v[52:53], v[52:53]
    v_pk_mul_f32 v[106:107], v[54:55], v[54:55]
    v_pk_fma_f32 v[104:105], v[104:105], s[26:27], v[30:31]
    v_pk_fma_f32 v[106:107], v[106:107], s[26:27], v[30:31]
    v_pk_mul_f32 v[104:105], v[104:105], v[52:53]
    v_pk_mul_f32 v[106:107], v[106:107], v[54:55]
    v_exp_f32 v104, v104
    v_exp_f32 v105, v105
    v_exp_f32 v106, v106
    v_exp_f32 v107, v107
    v_pk_add_f32 v[104:105], v[104:105], 1.0 op_sel_hi:[1,0]
    v_pk_add_f32 v[106:107], v[106:107], 1.0 op_sel_hi:[1,0]
    v_rcp_f32 v104, v104
    v_rcp_f32 v105, v105
    v_rcp_f32 v106, v106
    v_rcp_f32 v107, v107
    v_pk_mul_f32 v[52:53], v[52:53], v[104:105]
    v_pk_mul_f32 v[54:55], v[54:55], v[106:107]
    v_cvt_pk_bf16_f32 v82, v52, v53
    v_cvt_pk_bf16_f32 v83, v54, v55
    ds_write_b64 v5, v[82:83] offset:32
    v_pk_fma_f32 v[56:57], v[120:121], v[128:129], v[56:57]
    v_pk_fma_f32 v[58:59], v[122:123], v[128:129], v[58:59]
    v_pk_mul_f32 v[56:57], v[56:57], v[130:131]
    v_pk_mul_f32 v[58:59], v[58:59], v[130:131]
    v_cvt_pk_bf16_f32 v96, v56, v57
    v_cvt_pk_bf16_f32 v97, v58, v59
    v_lshlrev_b32 v56, 16, v96
    v_and_b32 v57, s23, v96
    v_lshlrev_b32 v58, 16, v97
    v_and_b32 v59, s23, v97
    v_pk_mul_f32 v[96:97], v[56:57], v[56:57]
    v_pk_mul_f32 v[98:99], v[58:59], v[58:59]
    v_pk_fma_f32 v[96:97], v[96:97], s[26:27], v[30:31]
    v_pk_fma_f32 v[98:99], v[98:99], s[26:27], v[30:31]
    v_pk_mul_f32 v[96:97], v[96:97], v[56:57]
    v_pk_mul_f32 v[98:99], v[98:99], v[58:59]
    v_exp_f32 v96, v96
    v_exp_f32 v97, v97
    v_exp_f32 v98, v98
    v_exp_f32 v99, v99
    v_pk_add_f32 v[96:97], v[96:97], 1.0 op_sel_hi:[1,0]
    v_pk_add_f32 v[98:99], v[98:99], 1.0 op_sel_hi:[1,0]
    v_rcp_f32 v96, v96
    v_rcp_f32 v97, v97
    v_rcp_f32 v98, v98
    v_rcp_f32 v99, v99
    v_pk_mul_f32 v[56:57], v[56:57], v[96:97]
    v_pk_mul_f32 v[58:59], v[58:59], v[98:99]
    v_cvt_pk_bf16_f32 v84, v56, v57
    v_cvt_pk_bf16_f32 v85, v58, v59
    ds_write_b64 v5, v[84:85] offset:64
    v_pk_fma_f32 v[60:61], v[124:125], v[128:129], v[60:61]
    v_pk_fma_f32 v[62:63], v[126:127], v[128:129], v[62:63]
    v_pk_mul_f32 v[60:61], v[60:61], v[130:131]
    v_pk_mul_f32 v[62:63], v[62:63], v[130:131]
    v_cvt_pk_bf16_f32 v104, v60, v61
    v_cvt_pk_bf16_f32 v105, v62, v63
    v_lshlrev_b32 v60, 16, v104
    v_and_b32 v61, s23, v104
    v_lshlrev_b32 v62, 16, v105
    v_and_b32 v63, s23, v105
    v_pk_mul_f32 v[104:105], v[60:61], v[60:61]
    v_pk_mul_f32 v[106:107], v[62:63], v[62:63]
    v_pk_fma_f32 v[104:105], v[104:105], s[26:27], v[30:31]
    v_pk_fma_f32 v[106:107], v[106:107], s[26:27], v[30:31]
    v_pk_mul_f32 v[104:105], v[104:105], v[60:61]
    v_pk_mul_f32 v[106:107], v[106:107], v[62:63]
    v_exp_f32 v104, v104
    v_exp_f32 v105, v105
    v_exp_f32 v106, v106
    v_exp_f32 v107, v107
    v_pk_add_f32 v[104:105], v[104:105], 1.0 op_sel_hi:[1,0]
    v_pk_add_f32 v[106:107], v[106:107], 1.0 op_sel_hi:[1,0]
    v_rcp_f32 v104, v104
    v_rcp_f32 v105, v105
    v_rcp_f32 v106, v106
    v_rcp_f32 v107, v107
    v_pk_mul_f32 v[60:61], v[60:61], v[104:105]
    v_pk_mul_f32 v[62:63], v[62:63], v[106:107]
    v_cvt_pk_bf16_f32 v86, v60, v61
    v_cvt_pk_bf16_f32 v87, v62, v63
    ds_write_b64 v5, v[86:87] offset:96
    s_waitcnt lgkmcnt(0)
    ds_read_b128 v[32:35], v8 offset:0
    ds_read_b128 v[36:39], v8 offset:1152
    s_waitcnt lgkmcnt(0)
    global_store_dwordx4 v7, v[32:35], s[48:49] sc1
    v_add_u32 v7, 28672, v7
    global_store_dwordx4 v7, v[36:39], s[48:49] sc1
    v_add_u32 v7, 28672, v7
    v_pk_fma_f32 v[64:65], v[112:113], v[136:137], v[64:65]
    v_pk_fma_f32 v[66:67], v[114:115], v[136:137], v[66:67]
    v_pk_mul_f32 v[64:65], v[64:65], v[138:139]
    v_pk_mul_f32 v[66:67], v[66:67], v[138:139]
    v_cvt_pk_bf16_f32 v96, v64, v65
    v_cvt_pk_bf16_f32 v97, v66, v67
    v_lshlrev_b32 v64, 16, v96
    v_and_b32 v65, s23, v96
    v_lshlrev_b32 v66, 16, v97
    v_and_b32 v67, s23, v97
    v_pk_mul_f32 v[96:97], v[64:65], v[64:65]
    v_pk_mul_f32 v[98:99], v[66:67], v[66:67]
    v_pk_fma_f32 v[96:97], v[96:97], s[26:27], v[30:31]
    v_pk_fma_f32 v[98:99], v[98:99], s[26:27], v[30:31]
    v_pk_mul_f32 v[96:97], v[96:97], v[64:65]
    v_pk_mul_f32 v[98:99], v[98:99], v[66:67]
    v_exp_f32 v96, v96
    v_exp_f32 v97, v97
    v_exp_f32 v98, v98
    v_exp_f32 v99, v99
    v_pk_add_f32 v[96:97], v[96:97], 1.0 op_sel_hi:[1,0]
    v_pk_add_f32 v[98:99], v[98:99], 1.0 op_sel_hi:[1,0]
    v_rcp_f32 v96, v96
    v_rcp_f32 v97, v97
    v_rcp_f32 v98, v98
    v_rcp_f32 v99, v99
    v_pk_mul_f32 v[64:65], v[64:65], v[96:97]
    v_pk_mul_f32 v[66:67], v[66:67], v[98:99]
    v_cvt_pk_bf16_f32 v80, v64, v65
    v_cvt_pk_bf16_f32 v81, v66, v67
    ds_write_b64 v5, v[80:81] offset:2304
    v_pk_fma_f32 v[68:69], v[116:117], v[136:137], v[68:69]
    v_pk_fma_f32 v[70:71], v[118:119], v[136:137], v[70:71]
    v_pk_mul_f32 v[68:69], v[68:69], v[138:139]
    v_pk_mul_f32 v[70:71], v[70:71], v[138:139]
    v_cvt_pk_bf16_f32 v104, v68, v69
    v_cvt_pk_bf16_f32 v105, v70, v71
    v_lshlrev_b32 v68, 16, v104
    v_and_b32 v69, s23, v104
    v_lshlrev_b32 v70, 16, v105
    v_and_b32 v71, s23, v105
    v_pk_mul_f32 v[104:105], v[68:69], v[68:69]
    v_pk_mul_f32 v[106:107], v[70:71], v[70:71]
    v_pk_fma_f32 v[104:105], v[104:105], s[26:27], v[30:31]
    v_pk_fma_f32 v[106:107], v[106:107], s[26:27], v[30:31]
    v_pk_mul_f32 v[104:105], v[104:105], v[68:69]
    v_pk_mul_f32 v[106:107], v[106:107], v[70:71]
    v_exp_f32 v104, v104
    v_exp_f32 v105, v105
    v_exp_f32 v106, v106
    v_exp_f32 v107, v107
    v_pk_add_f32 v[104:105], v[104:105], 1.0 op_sel_hi:[1,0]
    v_pk_add_f32 v[106:107], v[106:107], 1.0 op_sel_hi:[1,0]
    v_rcp_f32 v104, v104
    v_rcp_f32 v105, v105
    v_rcp_f32 v106, v106
    v_rcp_f32 v107, v107
    v_pk_mul_f32 v[68:69], v[68:69], v[104:105]
    v_pk_mul_f32 v[70:71], v[70:71], v[106:107]
    v_cvt_pk_bf16_f32 v82, v68, v69
    v_cvt_pk_bf16_f32 v83, v70, v71
    ds_write_b64 v5, v[82:83] offset:2336
    v_pk_fma_f32 v[72:73], v[120:121], v[136:137], v[72:73]
    v_pk_fma_f32 v[74:75], v[122:123], v[136:137], v[74:75]
    v_pk_mul_f32 v[72:73], v[72:73], v[138:139]
    v_pk_mul_f32 v[74:75], v[74:75], v[138:139]
    v_cvt_pk_bf16_f32 v96, v72, v73
    v_cvt_pk_bf16_f32 v97, v74, v75
    v_lshlrev_b32 v72, 16, v96
    v_and_b32 v73, s23, v96
    v_lshlrev_b32 v74, 16, v97
    v_and_b32 v75, s23, v97
    v_pk_mul_f32 v[96:97], v[72:73], v[72:73]
    v_pk_mul_f32 v[98:99], v[74:75], v[74:75]
    v_pk_fma_f32 v[96:97], v[96:97], s[26:27], v[30:31]
    v_pk_fma_f32 v[98:99], v[98:99], s[26:27], v[30:31]
    v_pk_mul_f32 v[96:97], v[96:97], v[72:73]
    v_pk_mul_f32 v[98:99], v[98:99], v[74:75]
    v_exp_f32 v96, v96
    v_exp_f32 v97, v97
    v_exp_f32 v98, v98
    v_exp_f32 v99, v99
    v_pk_add_f32 v[96:97], v[96:97], 1.0 op_sel_hi:[1,0]
    v_pk_add_f32 v[98:99], v[98:99], 1.0 op_sel_hi:[1,0]
    v_rcp_f32 v96, v96
    v_rcp_f32 v97, v97
    v_rcp_f32 v98, v98
    v_rcp_f32 v99, v99
    v_pk_mul_f32 v[72:73], v[72:73], v[96:97]
    v_pk_mul_f32 v[74:75], v[74:75], v[98:99]
    v_cvt_pk_bf16_f32 v84, v72, v73
    v_cvt_pk_bf16_f32 v85, v74, v75
    ds_write_b64 v5, v[84:85] offset:2368
    v_pk_fma_f32 v[76:77], v[124:125], v[136:137], v[76:77]
    v_pk_fma_f32 v[78:79], v[126:127], v[136:137], v[78:79]
    v_pk_mul_f32 v[76:77], v[76:77], v[138:139]
    v_pk_mul_f32 v[78:79], v[78:79], v[138:139]
    v_cvt_pk_bf16_f32 v104, v76, v77
    v_cvt_pk_bf16_f32 v105, v78, v79
    v_lshlrev_b32 v76, 16, v104
    v_and_b32 v77, s23, v104
    v_lshlrev_b32 v78, 16, v105
    v_and_b32 v79, s23, v105
    v_pk_mul_f32 v[104:105], v[76:77], v[76:77]
    v_pk_mul_f32 v[106:107], v[78:79], v[78:79]
    v_pk_fma_f32 v[104:105], v[104:105], s[26:27], v[30:31]
    v_pk_fma_f32 v[106:107], v[106:107], s[26:27], v[30:31]
    v_pk_mul_f32 v[104:105], v[104:105], v[76:77]
    v_pk_mul_f32 v[106:107], v[106:107], v[78:79]
    v_exp_f32 v104, v104
    v_exp_f32 v105, v105
    v_exp_f32 v106, v106
    v_exp_f32 v107, v107
    v_pk_add_f32 v[104:105], v[104:105], 1.0 op_sel_hi:[1,0]
    v_pk_add_f32 v[106:107], v[106:107], 1.0 op_sel_hi:[1,0]
    v_rcp_f32 v104, v104
    v_rcp_f32 v105, v105
    v_rcp_f32 v106, v106
    v_rcp_f32 v107, v107
    v_pk_mul_f32 v[76:77], v[76:77], v[104:105]
    v_pk_mul_f32 v[78:79], v[78:79], v[106:107]
    v_cvt_pk_bf16_f32 v86, v76, v77
    v_cvt_pk_bf16_f32 v87, v78, v79
    ds_write_b64 v5, v[86:87] offset:2400
    s_waitcnt lgkmcnt(0)
    ds_read_b128 v[32:35], v8 offset:2304
    ds_read_b128 v[36:39], v8 offset:3456
    s_waitcnt lgkmcnt(0)
    global_store_dwordx4 v7, v[32:35], s[48:49] sc1
    v_add_u32 v7, 28672, v7
    global_store_dwordx4 v7, v[36:39], s[48:49] sc1
    v_add_u32 v7, 28672, v7
K5_CODE_END:
K5_END:
    s_endpgm
.globl k6_kernel
.p2align 8
.type k6_kernel,@function
k6_kernel:
    s_cmp_ge_u32 s2, 256
    s_cbranch_scc1 K6_END
    s_load_dwordx8 s[64:71], s[0:1], 80
    s_load_dwordx4 s[72:75], s[0:1], 112
    s_load_dwordx2 s[32:33], s[0:1], 128
    v_lshrrev_b32 v1, 6, v0
    s_nop 0
    v_readfirstlane_b32 s8, v1
    v_and_b32 v2, 63, v0
    v_and_b32 v9, 15, v0
    v_bfe_u32 v10, v0, 4, 2
    s_waitcnt lgkmcnt(0)
    s_cmp_ge_u32 s8, 4
    s_cbranch_scc1 K6_C
    s_getpc_b64 s[76:77]
K6_PC:
    v_lshlrev_b32 v1, 4, v0
    global_load_dwordx4 v[120:123], v1, s[76:77]
    v_add_u32 v1, 0x1000, v1
    v_cmp_gt_u32 vcc, K6_CODE_END-K6_PC-16, v1
    s_and_saveexec_b64 s[78:79], vcc
    s_cbranch_execz K6_NOPF
    global_load_dwordx4 v[124:127], v1, s[76:77]
K6_NOPF:
    s_mov_b64 exec, -1
    s_mov_b32 s16, s70
    s_mov_b32 s17, s71
    s_and_b32 s4, s2, 7
    s_lshl_b32 s4, s4, 2
    s_lshr_b32 s5, s2, 6
    s_add_u32 s4, s4, s5
    s_bfe_u32 s5, s2, 0x30003
    v_lshrrev_b32 v4, 3, v2
    v_bfe_u32 v5, v2, 4, 1
    v_lshlrev_b32 v5, 1, v5
    s_and_b32 s3, s8, 1
    s_lshl_b32 s3, s3, 2
    v_or_b32 v5, s3, v5
    v_and_b32 v1, 7, v2
    v_xor_b32 v5, v1, v5
    v_mul_u32_u24 v4, 1024, v4
    v_lshl_add_u32 v4, v5, 4, v4
    v_lshrrev_b32 v3, 3, v2
    v_and_b32 v1, 7, v2
    v_xor_b32 v1, v3, v1
    v_mul_u32_u24 v3, 3584, v3
    v_lshl_add_u32 v3, v1, 4, v3
    s_lshl_b32 s7, s5, 7
    s_lshl_b32 s3, s8, 13
    s_add_u32 s7, s7, s3
    s_mul_i32 s6, s4, 229376
    s_mul_i32 s3, s8, 28672
    s_add_u32 s6, s6, s3
    s_lshl_b32 s15, s8, 10
    s_lshl_b32 s13, s4, 16
    s_lshl_b32 s3, s8, 13
    s_add_u32 s13, s13, s3
    s_lshl_b32 s3, s5, 7
    s_add_u32 s13, s13, s3
    s_waitcnt lgkmcnt(0)
    v_lshrrev_b32 v6, 3, v2
    v_lshlrev_b32 v6, 10, v6
    v_and_b32 v1, 7, v2
    v_lshl_add_u32 v6, v1, 4, v6
    s_add_u32 s36, s32, 21102592
    s_addc_u32 s37, s33, 0
    s_mov_b32 s38, 7340032
    s_mov_b32 s39, 0x00020000
    s_add_u32 s40, s16, 0
    s_addc_u32 s41, s17, 0
    s_mov_b32 s42, 1835008
    s_mov_b32 s43, 0x00020000
    s_add_u32 s44, s32, 0
    s_addc_u32 s45, s33, 0
    s_mov_b32 s46, 33554432
    s_mov_b32 s47, 0x00020000
    s_add_u32 m0, s15, 0
    s_nop 0
    buffer_load_dwordx4 v3, s[36:39], s6 offen lds
    s_add_u32 m0, s15, 8192
    s_nop 0
    buffer_load_dwordx4 v4, s[40:43], s7 offen lds
    s_add_u32 m0, s15, 4096
    s_add_u32 s3, s6, 114688
    buffer_load_dwordx4 v3, s[36:39], s3 offen lds
    s_add_u32 m0, s15, 12288
    s_add_u32 s3, s7, 32768
    buffer_load_dwordx4 v4, s[40:43], s3 offen lds
    s_add_u32 m0, s15, 16384
    s_add_u32 s3, s6, 128
    buffer_load_dwordx4 v3, s[36:39], s3 offen lds
    s_add_u32 m0, s15, 24576
    s_add_u32 s3, s7, 65536
    buffer_load_dwordx4 v4, s[40:43], s3 offen lds
    s_add_u32 m0, s15, 20480
    s_add_u32 s3, s6, 114816
    buffer_load_dwordx4 v3, s[36:39], s3 offen lds
    s_add_u32 m0, s15, 28672
    s_add_u32 s3, s7, 98304
    buffer_load_dwordx4 v4, s[40:43], s3 offen lds
    s_waitcnt vmcnt(4)
    s_barrier
    s_add_u32 m0, s15, 32768
    s_add_u32 s3, s6, 256
    buffer_load_dwordx4 v3, s[36:39], s3 offen lds
    s_add_u32 m0, s15, 40960
    s_add_u32 s3, s7, 131072
    buffer_load_dwordx4 v4, s[40:43], s3 offen lds
    s_add_u32 m0, s15, 36864
    s_add_u32 s3, s6, 114944
    buffer_load_dwordx4 v3, s[36:39], s3 offen lds
    s_add_u32 m0, s15, 45056
    s_add_u32 s3, s7, 163840
    buffer_load_dwordx4 v4, s[40:43], s3 offen lds
    s_add_u32 m0, s15, 49152
    s_add_u32 s3, s6, 384
    buffer_load_dwordx4 v3, s[36:39], s3 offen lds
    s_add_u32 m0, s15, 57344
    s_add_u32 s3, s7, 196608
    buffer_load_dwordx4 v4, s[40:43], s3 offen lds
    s_add_u32 m0, s15, 53248
    s_add_u32 s3, s6, 115072
    buffer_load_dwordx4 v3, s[36:39], s3 offen lds
    s_add_u32 m0, s15, 61440
    s_add_u32 s3, s7, 229376
    buffer_load_dwordx4 v4, s[40:43], s3 offen lds
    s_waitcnt vmcnt(8)
    s_barrier
    s_add_u32 m0, s15, 65536
    s_add_u32 s3, s6, 512
    buffer_load_dwordx4 v3, s[36:39], s3 offen lds
    s_add_u32 m0, s15, 73728
    s_add_u32 s3, s7, 262144
    buffer_load_dwordx4 v4, s[40:43], s3 offen lds
    s_add_u32 m0, s15, 69632
    s_add_u32 s3, s6, 115200
    buffer_load_dwordx4 v3, s[36:39], s3 offen lds
    s_add_u32 m0, s15, 77824
    s_add_u32 s3, s7, 294912
    buffer_load_dwordx4 v4, s[40:43], s3 offen lds
    s_add_u32 m0, s15, 81920
    s_add_u32 s3, s6, 640
    buffer_load_dwordx4 v3, s[36:39], s3 offen lds
    s_add_u32 m0, s15, 90112
    s_add_u32 s3, s7, 327680
    buffer_load_dwordx4 v4, s[40:43], s3 offen lds
    s_add_u32 m0, s15, 86016
    s_add_u32 s3, s6, 115328
    buffer_load_dwordx4 v3, s[36:39], s3 offen lds
    s_add_u32 m0, s15, 94208
    s_add_u32 s3, s7, 360448
    buffer_load_dwordx4 v4, s[40:43], s3 offen lds
    s_waitcnt vmcnt(12)
    s_barrier
    s_add_u32 m0, s15, 98304
    s_add_u32 s3, s6, 768
    buffer_load_dwordx4 v3, s[36:39], s3 offen lds
    s_add_u32 m0, s15, 106496
    s_add_u32 s3, s7, 393216
    buffer_load_dwordx4 v4, s[40:43], s3 offen lds
    s_add_u32 m0, s15, 102400
    s_add_u32 s3, s6, 115456
    buffer_load_dwordx4 v3, s[36:39], s3 offen lds
    s_add_u32 m0, s15, 110592
    s_add_u32 s3, s7, 425984
    buffer_load_dwordx4 v4, s[40:43], s3 offen lds
    s_add_u32 m0, s15, 114688
    s_add_u32 s3, s6, 896
    buffer_load_dwordx4 v3, s[36:39], s3 offen lds
    s_add_u32 m0, s15, 122880
    s_add_u32 s3, s7, 458752
    buffer_load_dwordx4 v4, s[40:43], s3 offen lds
    s_add_u32 m0, s15, 118784
    s_add_u32 s3, s6, 115584
    buffer_load_dwordx4 v3, s[36:39], s3 offen lds
    s_add_u32 m0, s15, 126976
    s_add_u32 s3, s7, 491520
    buffer_load_dwordx4 v4, s[40:43], s3 offen lds
    s_waitcnt vmcnt(16)
    s_barrier
    s_add_u32 m0, s15, 0
    s_add_u32 s3, s6, 1024
    buffer_load_dwordx4 v3, s[36:39], s3 offen lds
    s_add_u32 m0, s15, 8192
    s_add_u32 s3, s7, 524288
    buffer_load_dwordx4 v4, s[40:43], s3 offen lds
    s_add_u32 m0, s15, 4096
    s_add_u32 s3, s6, 115712
    buffer_load_dwordx4 v3, s[36:39], s3 offen lds
    s_add_u32 m0, s15, 12288
    s_add_u32 s3, s7, 557056
    buffer_load_dwordx4 v4, s[40:43], s3 offen lds
    s_add_u32 m0, s15, 16384
    s_add_u32 s3, s6, 1152
    buffer_load_dwordx4 v3, s[36:39], s3 offen lds
    s_add_u32 m0, s15, 24576
    s_add_u32 s3, s7, 589824
    buffer_load_dwordx4 v4, s[40:43], s3 offen lds
    s_add_u32 m0, s15, 20480
    s_add_u32 s3, s6, 115840
    buffer_load_dwordx4 v3, s[36:39], s3 offen lds
    s_add_u32 m0, s15, 28672
    s_add_u32 s3, s7, 622592
    buffer_load_dwordx4 v4, s[40:43], s3 offen lds
    s_waitcnt vmcnt(20)
    s_barrier
    s_add_u32 m0, s15, 32768
    s_add_u32 s3, s6, 1280
    buffer_load_dwordx4 v3, s[36:39], s3 offen lds
    s_add_u32 m0, s15, 40960
    s_add_u32 s3, s7, 655360
    buffer_load_dwordx4 v4, s[40:43], s3 offen lds
    s_add_u32 m0, s15, 36864
    s_add_u32 s3, s6, 115968
    buffer_load_dwordx4 v3, s[36:39], s3 offen lds
    s_add_u32 m0, s15, 45056
    s_add_u32 s3, s7, 688128
    buffer_load_dwordx4 v4, s[40:43], s3 offen lds
    s_waitcnt vmcnt(20)
    s_barrier
    s_add_u32 m0, s15, 49152
    s_add_u32 s3, s6, 1408
    buffer_load_dwordx4 v3, s[36:39], s3 offen lds
    s_add_u32 m0, s15, 57344
    s_add_u32 s3, s7, 720896
    buffer_load_dwordx4 v4, s[40:43], s3 offen lds
    s_add_u32 m0, s15, 53248
    s_add_u32 s3, s6, 116096
    buffer_load_dwordx4 v3, s[36:39], s3 offen lds
    s_add_u32 m0, s15, 61440
    s_add_u32 s3, s7, 753664
    buffer_load_dwordx4 v4, s[40:43], s3 offen lds
    s_waitcnt vmcnt(20)
    s_barrier
    s_add_u32 m0, s15, 65536
    s_add_u32 s3, s6, 1536
    buffer_load_dwordx4 v3, s[36:39], s3 offen lds
    s_add_u32 m0, s15, 73728
    s_add_u32 s3, s7, 786432
    buffer_load_dwordx4 v4, s[40:43], s3 offen lds
    s_add_u32 m0, s15, 69632
    s_add_u32 s3, s6, 116224
    buffer_load_dwordx4 v3, s[36:39], s3 offen lds
    s_add_u32 m0, s15, 77824
    s_add_u32 s3, s7, 819200
    buffer_load_dwordx4 v4, s[40:43], s3 offen lds
    s_add_u32 m0, s15, 131072
    s_add_u32 s3, s13, 18939904
    buffer_load_dwordx4 v6, s[44:47], s3 offen lds
    s_add_u32 m0, s15, 139264
    s_add_u32 s3, s13, 12582912
    buffer_load_dwordx4 v6, s[44:47], s3 offen lds
    s_add_u32 m0, s15, 135168
    s_add_u32 s3, s13, 18972672
    buffer_load_dwordx4 v6, s[44:47], s3 offen lds
    s_add_u32 m0, s15, 143360
    s_add_u32 s3, s13, 12615680
    buffer_load_dwordx4 v6, s[44:47], s3 offen lds
    s_waitcnt vmcnt(24)
    s_barrier
    s_add_u32 m0, s15, 81920
    s_add_u32 s3, s6, 1664
    buffer_load_dwordx4 v3, s[36:39], s3 offen lds
    s_add_u32 m0, s15, 90112
    s_add_u32 s3, s7, 851968
    buffer_load_dwordx4 v4, s[40:43], s3 offen lds
    s_add_u32 m0, s15, 86016
    s_add_u32 s3, s6, 116352
    buffer_load_dwordx4 v3, s[36:39], s3 offen lds
    s_add_u32 m0, s15, 94208
    s_add_u32 s3, s7, 884736
    buffer_load_dwordx4 v4, s[40:43], s3 offen lds
    s_waitcnt vmcnt(24)
    s_barrier
    s_add_u32 m0, s15, 98304
    s_add_u32 s3, s6, 1792
    buffer_load_dwordx4 v3, s[36:39], s3 offen lds
    s_add_u32 m0, s15, 106496
    s_add_u32 s3, s7, 917504
    buffer_load_dwordx4 v4, s[40:43], s3 offen lds
    s_add_u32 m0, s15, 102400
    s_add_u32 s3, s6, 116480
    buffer_load_dwordx4 v3, s[36:39], s3 offen lds
    s_add_u32 m0, s15, 110592
    s_add_u32 s3, s7, 950272
    buffer_load_dwordx4 v4, s[40:43], s3 offen lds
    s_waitcnt vmcnt(24)
    s_barrier
    s_add_u32 m0, s15, 114688
    s_add_u32 s3, s6, 1920
    buffer_load_dwordx4 v3, s[36:39], s3 offen lds
    s_add_u32 m0, s15, 122880
    s_add_u32 s3, s7, 983040
    buffer_load_dwordx4 v4, s[40:43], s3 offen lds
    s_add_u32 m0, s15, 118784
    s_add_u32 s3, s6, 116608
    buffer_load_dwordx4 v3, s[36:39], s3 offen lds
    s_add_u32 m0, s15, 126976
    s_add_u32 s3, s7, 1015808
    buffer_load_dwordx4 v4, s[40:43], s3 offen lds
    s_waitcnt vmcnt(24)
    s_barrier
    s_add_u32 m0, s15, 0
    s_add_u32 s3, s6, 2048
    buffer_load_dwordx4 v3, s[36:39], s3 offen lds
    s_add_u32 m0, s15, 8192
    s_add_u32 s3, s7, 1048576
    buffer_load_dwordx4 v4, s[40:43], s3 offen lds
    s_add_u32 m0, s15, 4096
    s_add_u32 s3, s6, 116736
    buffer_load_dwordx4 v3, s[36:39], s3 offen lds
    s_add_u32 m0, s15, 12288
    s_add_u32 s3, s7, 1081344
    buffer_load_dwordx4 v4, s[40:43], s3 offen lds
    s_waitcnt vmcnt(24)
    s_barrier
    s_add_u32 m0, s15, 16384
    s_add_u32 s3, s6, 2176
    buffer_load_dwordx4 v3, s[36:39], s3 offen lds
    s_add_u32 m0, s15, 24576
    s_add_u32 s3, s7, 1114112
    buffer_load_dwordx4 v4, s[40:43], s3 offen lds
    s_add_u32 m0, s15, 20480
    s_add_u32 s3, s6, 116864
    buffer_load_dwordx4 v3, s[36:39], s3 offen lds
    s_add_u32 m0, s15, 28672
    s_add_u32 s3, s7, 1146880
    buffer_load_dwordx4 v4, s[40:43], s3 offen lds
    s_waitcnt vmcnt(20)
    s_barrier
    s_add_u32 m0, s15, 32768
    s_add_u32 s3, s6, 2304
    buffer_load_dwordx4 v3, s[36:39], s3 offen lds
    s_add_u32 m0, s15, 40960
    s_add_u32 s3, s7, 1179648
    buffer_load_dwordx4 v4, s[40:43], s3 offen lds
    s_add_u32 m0, s15, 36864
    s_add_u32 s3, s6, 116992
    buffer_load_dwordx4 v3, s[36:39], s3 offen lds
    s_add_u32 m0, s15, 45056
    s_add_u32 s3, s7, 1212416
    buffer_load_dwordx4 v4, s[40:43], s3 offen lds
    s_waitcnt vmcnt(20)
    s_barrier
    s_add_u32 m0, s15, 49152
    s_add_u32 s3, s6, 2432
    buffer_load_dwordx4 v3, s[36:39], s3 offen lds
    s_add_u32 m0, s15, 57344
    s_add_u32 s3, s7, 1245184
    buffer_load_dwordx4 v4, s[40:43], s3 offen lds
    s_add_u32 m0, s15, 53248
    s_add_u32 s3, s6, 117120
    buffer_load_dwordx4 v3, s[36:39], s3 offen lds
    s_add_u32 m0, s15, 61440
    s_add_u32 s3, s7, 1277952
    buffer_load_dwordx4 v4, s[40:43], s3 offen lds
    s_waitcnt vmcnt(20)
    s_barrier
    s_add_u32 m0, s15, 65536
    s_add_u32 s3, s6, 2560
    buffer_load_dwordx4 v3, s[36:39], s3 offen lds
    s_add_u32 m0, s15, 73728
    s_add_u32 s3, s7, 1310720
    buffer_load_dwordx4 v4, s[40:43], s3 offen lds
    s_add_u32 m0, s15, 69632
    s_add_u32 s3, s6, 117248
    buffer_load_dwordx4 v3, s[36:39], s3 offen lds
    s_add_u32 m0, s15, 77824
    s_add_u32 s3, s7, 1343488
    buffer_load_dwordx4 v4, s[40:43], s3 offen lds
    s_waitcnt vmcnt(20)
    s_barrier
    s_add_u32 m0, s15, 81920
    s_add_u32 s3, s6, 2688
    buffer_load_dwordx4 v3, s[36:39], s3 offen lds
    s_add_u32 m0, s15, 90112
    s_add_u32 s3, s7, 1376256
    buffer_load_dwordx4 v4, s[40:43], s3 offen lds
    s_add_u32 m0, s15, 86016
    s_add_u32 s3, s6, 117376
    buffer_load_dwordx4 v3, s[36:39], s3 offen lds
    s_add_u32 m0, s15, 94208
    s_add_u32 s3, s7, 1409024
    buffer_load_dwordx4 v4, s[40:43], s3 offen lds
    s_waitcnt vmcnt(20)
    s_barrier
    s_add_u32 m0, s15, 98304
    s_add_u32 s3, s6, 2816
    buffer_load_dwordx4 v3, s[36:39], s3 offen lds
    s_add_u32 m0, s15, 106496
    s_add_u32 s3, s7, 1441792
    buffer_load_dwordx4 v4, s[40:43], s3 offen lds
    s_add_u32 m0, s15, 102400
    s_add_u32 s3, s6, 117504
    buffer_load_dwordx4 v3, s[36:39], s3 offen lds
    s_add_u32 m0, s15, 110592
    s_add_u32 s3, s7, 1474560
    buffer_load_dwordx4 v4, s[40:43], s3 offen lds
    s_waitcnt vmcnt(20)
    s_barrier
    s_add_u32 m0, s15, 114688
    s_add_u32 s3, s6, 2944
    buffer_load_dwordx4 v3, s[36:39], s3 offen lds
    s_add_u32 m0, s15, 122880
    s_add_u32 s3, s7, 1507328
    buffer_load_dwordx4 v4, s[40:43], s3 offen lds
    s_add_u32 m0, s15, 118784
    s_add_u32 s3, s6, 117632
    buffer_load_dwordx4 v3, s[36:39], s3 offen lds
    s_add_u32 m0, s15, 126976
    s_add_u32 s3, s7, 1540096
    buffer_load_dwordx4 v4, s[40:43], s3 offen lds
    s_waitcnt vmcnt(20)
    s_barrier
    s_add_u32 m0, s15, 0
    s_add_u32 s3, s6, 3072
    buffer_load_dwordx4 v3, s[36:39], s3 offen lds
    s_add_u32 m0, s15, 8192
    s_add_u32 s3, s7, 1572864
    buffer_load_dwordx4 v4, s[40:43], s3 offen lds
    s_add_u32 m0, s15, 4096
    s_add_u32 s3, s6, 117760
    buffer_load_dwordx4 v3, s[36:39], s3 offen lds
    s_add_u32 m0, s15, 12288
    s_add_u32 s3, s7, 1605632
    buffer_load_dwordx4 v4, s[40:43], s3 offen lds
    s_waitcnt vmcnt(20)
    s_barrier
    s_add_u32 m0, s15, 16384
    s_add_u32 s3, s6, 3200
    buffer_load_dwordx4 v3, s[36:39], s3 offen lds
    s_add_u32 m0, s15, 24576
    s_add_u32 s3, s7, 1638400
    buffer_load_dwordx4 v4, s[40:43], s3 offen lds
    s_add_u32 m0, s15, 20480
    s_add_u32 s3, s6, 117888
    buffer_load_dwordx4 v3, s[36:39], s3 offen lds
    s_add_u32 m0, s15, 28672
    s_add_u32 s3, s7, 1671168
    buffer_load_dwordx4 v4, s[40:43], s3 offen lds
    s_waitcnt vmcnt(20)
    s_barrier
    s_add_u32 m0, s15, 32768
    s_add_u32 s3, s6, 3328
    buffer_load_dwordx4 v3, s[36:39], s3 offen lds
    s_add_u32 m0, s15, 40960
    s_add_u32 s3, s7, 1703936
    buffer_load_dwordx4 v4, s[40:43], s3 offen lds
    s_add_u32 m0, s15, 36864
    s_add_u32 s3, s6, 118016
    buffer_load_dwordx4 v3, s[36:39], s3 offen lds
    s_add_u32 m0, s15, 45056
    s_add_u32 s3, s7, 1736704
    buffer_load_dwordx4 v4, s[40:43], s3 offen lds
    s_waitcnt vmcnt(20)
    s_barrier
    s_add_u32 m0, s15, 49152
    s_add_u32 s3, s6, 3456
    buffer_load_dwordx4 v3, s[36:39], s3 offen lds
    s_add_u32 m0, s15, 57344
    s_add_u32 s3, s7, 1769472
    buffer_load_dwordx4 v4, s[40:43], s3 offen lds
    s_add_u32 m0, s15, 53248
    s_add_u32 s3, s6, 118144
    buffer_load_dwordx4 v3, s[36:39], s3 offen lds
    s_add_u32 m0, s15, 61440
    s_add_u32 s3, s7, 1802240
    buffer_load_dwordx4 v4, s[40:43], s3 offen lds
    s_waitcnt vmcnt(20)
    s_barrier
    s_waitcnt vmcnt(16)
    s_barrier
    s_waitcnt vmcnt(12)
    s_barrier
    s_waitcnt vmcnt(8)
    s_barrier
    s_waitcnt vmcnt(4)
    s_barrier
    s_waitcnt vmcnt(0)
    s_barrier
    s_endpgm
K6_C:
    s_sub_u32 s8, s8, 4
    s_and_b32 s4, s2, 7
    s_lshl_b32 s4, s4, 2
    s_lshr_b32 s5, s2, 6
    s_add_u32 s4, s4, s5
    s_bfe_u32 s5, s2, 0x30003
    s_bfe_u32 s9, s8, 0x10001
    s_and_b32 s10, s8, 1
    s_lshr_b32 s11, s8, 2
    s_lshl_b32 s14, s10, 2
    s_add_u32 s15, s14, 2
    s_lshl_b32 s28, s11, 12
    s_lshl_b32 s29, s11, 6
    v_bfe_u32 v5, v9, 3, 1
    v_lshlrev_b32 v5, 1, v5
    v_and_b32 v6, 1, v10
    v_lshl_or_b32 v5, v6, 2, v5
    v_bfe_u32 v6, v9, 1, 1
    v_add_u32 v6, s14, v6
    v_xor_b32 v5, v5, v6
    v_lshlrev_b32 v5, 4, v5
    v_and_b32 v6, 1, v9
    v_lshl_add_u32 v5, v6, 3, v5
    v_lshrrev_b32 v6, 2, v9
    v_lshl_add_u32 v6, v10, 3, v6
    v_lshl_add_u32 v12, v6, 7, v5
    v_add_u32 v12, 8192, v12
    v_bfe_u32 v5, v9, 3, 1
    v_lshlrev_b32 v5, 1, v5
    v_and_b32 v6, 1, v10
    v_lshl_or_b32 v5, v6, 2, v5
    v_bfe_u32 v6, v9, 1, 1
    v_add_u32 v6, s15, v6
    v_xor_b32 v5, v5, v6
    v_lshlrev_b32 v5, 4, v5
    v_and_b32 v6, 1, v9
    v_lshl_add_u32 v5, v6, 3, v5
    v_lshrrev_b32 v6, 2, v9
    v_lshl_add_u32 v6, v10, 3, v6
    v_lshl_add_u32 v13, v6, 7, v5
    v_add_u32 v13, 8192, v13
    v_add_u32 v12, s28, v12
    v_add_u32 v14, 0x10000, v12
    v_add_u32 v13, s28, v13
    v_add_u32 v15, 0x10000, v13
    v_and_b32 v5, 7, v9
    v_xor_b32 v5, v10, v5
    v_lshlrev_b32 v5, 4, v5
    s_lshl_b32 s3, s9, 12
    v_lshl_add_u32 v104, v9, 7, v5
    v_add_u32 v104, s3, v104
    v_xor_b32 v104, s29, v104
    v_add_u32 v105, 0x10000, v104
    v_mov_b32 v80, 0
    v_mov_b32 v81, 0
    v_mov_b32 v82, 0
    v_mov_b32 v83, 0
    v_mov_b32 v84, 0
    v_mov_b32 v85, 0
    v_mov_b32 v86, 0
    v_mov_b32 v87, 0
    v_mov_b32 v88, 0
    v_mov_b32 v89, 0
    v_mov_b32 v90, 0
    v_mov_b32 v91, 0
    v_mov_b32 v92, 0
    v_mov_b32 v93, 0
    v_mov_b32 v94, 0
    v_mov_b32 v95, 0
    s_mov_b32 s23, 0xffff0000
    s_barrier
    ds_read_b128 v[32:35], v104 offset:0
    ds_read_b128 v[36:39], v104 offset:2048
    ds_read_b64_tr_b16 v[56:57], v12 offset:0
    ds_read_b64_tr_b16 v[58:59], v12 offset:512
    ds_read_b64_tr_b16 v[60:61], v13 offset:0
    ds_read_b64_tr_b16 v[62:63], v13 offset:512
    s_barrier
    ds_read_b128 v[40:43], v104 offset:16384
    ds_read_b128 v[44:47], v104 offset:18432
    ds_read_b64_tr_b16 v[64:65], v12 offset:16384
    ds_read_b64_tr_b16 v[66:67], v12 offset:16896
    ds_read_b64_tr_b16 v[68:69], v13 offset:16384
    ds_read_b64_tr_b16 v[70:71], v13 offset:16896
    s_waitcnt lgkmcnt(6)
    v_mfma_f32_16x16x32_bf16 v[80:83], v[56:59], v[32:35], v[80:83]
    v_mfma_f32_16x16x32_bf16 v[84:87], v[60:63], v[32:35], v[84:87]
    v_mfma_f32_16x16x32_bf16 v[88:91], v[56:59], v[36:39], v[88:91]
    v_mfma_f32_16x16x32_bf16 v[92:95], v[60:63], v[36:39], v[92:95]
    s_barrier
    ds_read_b128 v[48:51], v104 offset:32768
    ds_read_b128 v[52:55], v104 offset:34816
    ds_read_b64_tr_b16 v[72:73], v12 offset:32768
    ds_read_b64_tr_b16 v[74:75], v12 offset:33280
    ds_read_b64_tr_b16 v[76:77], v13 offset:32768
    ds_read_b64_tr_b16 v[78:79], v13 offset:33280
    s_waitcnt lgkmcnt(6)
    v_mfma_f32_16x16x32_bf16 v[80:83], v[64:67], v[40:43], v[80:83]
    v_mfma_f32_16x16x32_bf16 v[84:87], v[68:71], v[40:43], v[84:87]
    v_mfma_f32_16x16x32_bf16 v[88:91], v[64:67], v[44:47], v[88:91]
    v_mfma_f32_16x16x32_bf16 v[92:95], v[68:71], v[44:47], v[92:95]
    s_barrier
    ds_read_b128 v[32:35], v104 offset:49152
    ds_read_b128 v[36:39], v104 offset:51200
    ds_read_b64_tr_b16 v[56:57], v12 offset:49152
    ds_read_b64_tr_b16 v[58:59], v12 offset:49664
    ds_read_b64_tr_b16 v[60:61], v13 offset:49152
    ds_read_b64_tr_b16 v[62:63], v13 offset:49664
    s_waitcnt lgkmcnt(6)
    v_mfma_f32_16x16x32_bf16 v[80:83], v[72:75], v[48:51], v[80:83]
    v_mfma_f32_16x16x32_bf16 v[84:87], v[76:79], v[48:51], v[84:87]
    v_mfma_f32_16x16x32_bf16 v[88:91], v[72:75], v[52:55], v[88:91]
    v_mfma_f32_16x16x32_bf16 v[92:95], v[76:79], v[52:55], v[92:95]
    s_barrier
    ds_read_b128 v[40:43], v105 offset:0
    ds_read_b128 v[44:47], v105 offset:2048
    ds_read_b64_tr_b16 v[64:65], v14 offset:0
    ds_read_b64_tr_b16 v[66:67], v14 offset:512
    ds_read_b64_tr_b16 v[68:69], v15 offset:0
    ds_read_b64_tr_b16 v[70:71], v15 offset:512
    s_waitcnt lgkmcnt(6)
    v_mfma_f32_16x16x32_bf16 v[80:83], v[56:59], v[32:35], v[80:83]
    v_mfma_f32_16x16x32_bf16 v[84:87], v[60:63], v[32:35], v[84:87]
    v_mfma_f32_16x16x32_bf16 v[88:91], v[56:59], v[36:39], v[88:91]
    v_mfma_f32_16x16x32_bf16 v[92:95], v[60:63], v[36:39], v[92:95]
    s_barrier
    ds_read_b128 v[48:51], v105 offset:16384
    ds_read_b128 v[52:55], v105 offset:18432
    ds_read_b64_tr_b16 v[72:73], v14 offset:16384
    ds_read_b64_tr_b16 v[74:75], v14 offset:16896
    ds_read_b64_tr_b16 v[76:77], v15 offset:16384
    ds_read_b64_tr_b16 v[78:79], v15 offset:16896
    s_waitcnt lgkmcnt(6)
    v_mfma_f32_16x16x32_bf16 v[80:83], v[64:67], v[40:43], v[80:83]
    v_mfma_f32_16x16x32_bf16 v[84:87], v[68:71], v[40:43], v[84:87]
    v_mfma_f32_16x16x32_bf16 v[88:91], v[64:67], v[44:47], v[88:91]
    v_mfma_f32_16x16x32_bf16 v[92:95], v[68:71], v[44:47], v[92:95]
    s_barrier
    ds_read_b128 v[32:35], v105 offset:32768
    ds_read_b128 v[36:39], v105 offset:34816
    ds_read_b64_tr_b16 v[56:57], v14 offset:32768
    ds_read_b64_tr_b16 v[58:59], v14 offset:33280
    ds_read_b64_tr_b16 v[60:61], v15 offset:32768
    ds_read_b64_tr_b16 v[62:63], v15 offset:33280
    s_waitcnt lgkmcnt(6)
    v_mfma_f32_16x16x32_bf16 v[80:83], v[72:75], v[48:51], v[80:83]
    v_mfma_f32_16x16x32_bf16 v[84:87], v[76:79], v[48:51], v[84:87]
    v_mfma_f32_16x16x32_bf16 v[88:91], v[72:75], v[52:55], v[88:91]
    v_mfma_f32_16x16x32_bf16 v[92:95], v[76:79], v[52:55], v[92:95]
    s_barrier
    ds_read_b128 v[40:43], v105 offset:49152
    ds_read_b128 v[44:47], v105 offset:51200
    ds_read_b64_tr_b16 v[64:65], v14 offset:49152
    ds_read_b64_tr_b16 v[66:67], v14 offset:49664
    ds_read_b64_tr_b16 v[68:69], v15 offset:49152
    ds_read_b64_tr_b16 v[70:71], v15 offset:49664
    s_waitcnt lgkmcnt(6)
    v_mfma_f32_16x16x32_bf16 v[80:83], v[56:59], v[32:35], v[80:83]
    v_mfma_f32_16x16x32_bf16 v[84:87], v[60:63], v[32:35], v[84:87]
    v_mfma_f32_16x16x32_bf16 v[88:91], v[56:59], v[36:39], v[88:91]
    v_mfma_f32_16x16x32_bf16 v[92:95], v[60:63], v[36:39], v[92:95]
    s_barrier
    ds_read_b128 v[48:51], v104 offset:0
    ds_read_b128 v[52:55], v104 offset:2048
    ds_read_b64_tr_b16 v[72:73], v12 offset:0
    ds_read_b64_tr_b16 v[74:75], v12 offset:512
    ds_read_b64_tr_b16 v[76:77], v13 offset:0
    ds_read_b64_tr_b16 v[78:79], v13 offset:512
    s_waitcnt lgkmcnt(6)
    v_mfma_f32_16x16x32_bf16 v[80:83], v[64:67], v[40:43], v[80:83]
    v_mfma_f32_16x16x32_bf16 v[84:87], v[68:71], v[40:43], v[84:87]
    v_mfma_f32_16x16x32_bf16 v[88:91], v[64:67], v[44:47], v[88:91]
    v_mfma_f32_16x16x32_bf16 v[92:95], v[68:71], v[44:47], v[92:95]
    s_barrier
    ds_read_b128 v[32:35], v104 offset:16384
    ds_read_b128 v[36:39], v104 offset:18432
    ds_read_b64_tr_b16 v[56:57], v12 offset:16384
    ds_read_b64_tr_b16 v[58:59], v12 offset:16896
    ds_read_b64_tr_b16 v[60:61], v13 offset:16384
    ds_read_b64_tr_b16 v[62:63], v13 offset:16896
    s_waitcnt lgkmcnt(6)
    v_mfma_f32_16x16x32_bf16 v[80:83], v[72:75], v[48:51], v[80:83]
    v_mfma_f32_16x16x32_bf16 v[84:87], v[76:79], v[48:51], v[84:87]
    v_mfma_f32_16x16x32_bf16 v[88:91], v[72:75], v[52:55], v[88:91]
    v_mfma_f32_16x16x32_bf16 v[92:95], v[76:79], v[52:55], v[92:95]
    s_barrier
    ds_read_b128 v[40:43], v104 offset:32768
    ds_read_b128 v[44:47], v104 offset:34816
    ds_read_b64_tr_b16 v[64:65], v12 offset:32768
    ds_read_b64_tr_b16 v[66:67], v12 offset:33280
    ds_read_b64_tr_b16 v[68:69], v13 offset:32768
    ds_read_b64_tr_b16 v[70:71], v13 offset:33280
    s_waitcnt lgkmcnt(6)
    v_mfma_f32_16x16x32_bf16 v[80:83], v[56:59], v[32:35], v[80:83]
    v_mfma_f32_16x16x32_bf16 v[84:87], v[60:63], v[32:35], v[84:87]
    v_mfma_f32_16x16x32_bf16 v[88:91], v[56:59], v[36:39], v[88:91]
    v_mfma_f32_16x16x32_bf16 v[92:95], v[60:63], v[36:39], v[92:95]
    s_barrier
    ds_read_b128 v[48:51], v104 offset:49152
    ds_read_b128 v[52:55], v104 offset:51200
    ds_read_b64_tr_b16 v[72:73], v12 offset:49152
    ds_read_b64_tr_b16 v[74:75], v12 offset:49664
    ds_read_b64_tr_b16 v[76:77], v13 offset:49152
    ds_read_b64_tr_b16 v[78:79], v13 offset:49664
    s_waitcnt lgkmcnt(6)
    v_mfma_f32_16x16x32_bf16 v[80:83], v[64:67], v[40:43], v[80:83]
    v_mfma_f32_16x16x32_bf16 v[84:87], v[68:71], v[40:43], v[84:87]
    v_mfma_f32_16x16x32_bf16 v[88:91], v[64:67], v[44:47], v[88:91]
    v_mfma_f32_16x16x32_bf16 v[92:95], v[68:71], v[44:47], v[92:95]
    s_barrier
    ds_read_b128 v[32:35], v105 offset:0
    ds_read_b128 v[36:39], v105 offset:2048
    ds_read_b64_tr_b16 v[56:57], v14 offset:0
    ds_read_b64_tr_b16 v[58:59], v14 offset:512
    ds_read_b64_tr_b16 v[60:61], v15 offset:0
    ds_read_b64_tr_b16 v[62:63], v15 offset:512
    s_waitcnt lgkmcnt(6)
    v_mfma_f32_16x16x32_bf16 v[80:83], v[72:75], v[48:51], v[80:83]
    v_mfma_f32_16x16x32_bf16 v[84:87], v[76:79], v[48:51], v[84:87]
    v_mfma_f32_16x16x32_bf16 v[88:91], v[72:75], v[52:55], v[88:91]
    v_mfma_f32_16x16x32_bf16 v[92:95], v[76:79], v[52:55], v[92:95]
    s_barrier
    ds_read_b128 v[40:43], v105 offset:16384
    ds_read_b128 v[44:47], v105 offset:18432
    ds_read_b64_tr_b16 v[64:65], v14 offset:16384
    ds_read_b64_tr_b16 v[66:67], v14 offset:16896
    ds_read_b64_tr_b16 v[68:69], v15 offset:16384
    ds_read_b64_tr_b16 v[70:71], v15 offset:16896
    s_waitcnt lgkmcnt(6)
    v_mfma_f32_16x16x32_bf16 v[80:83], v[56:59], v[32:35], v[80:83]
    v_mfma_f32_16x16x32_bf16 v[84:87], v[60:63], v[32:35], v[84:87]
    v_mfma_f32_16x16x32_bf16 v[88:91], v[56:59], v[36:39], v[88:91]
    v_mfma_f32_16x16x32_bf16 v[92:95], v[60:63], v[36:39], v[92:95]
    s_barrier
    ds_read_b128 v[48:51], v105 offset:32768
    ds_read_b128 v[52:55], v105 offset:34816
    ds_read_b64_tr_b16 v[72:73], v14 offset:32768
    ds_read_b64_tr_b16 v[74:75], v14 offset:33280
    ds_read_b64_tr_b16 v[76:77], v15 offset:32768
    ds_read_b64_tr_b16 v[78:79], v15 offset:33280
    s_waitcnt lgkmcnt(6)
    v_mfma_f32_16x16x32_bf16 v[80:83], v[64:67], v[40:43], v[80:83]
    v_mfma_f32_16x16x32_bf16 v[84:87], v[68:71], v[40:43], v[84:87]
    v_mfma_f32_16x16x32_bf16 v[88:91], v[64:67], v[44:47], v[88:91]
    v_mfma_f32_16x16x32_bf16 v[92:95], v[68:71], v[44:47], v[92:95]
    s_barrier
    ds_read_b128 v[32:35], v105 offset:49152
    ds_read_b128 v[36:39], v105 offset:51200
    ds_read_b64_tr_b16 v[56:57], v14 offset:49152
    ds_read_b64_tr_b16 v[58:59], v14 offset:49664
    ds_read_b64_tr_b16 v[60:61], v15 offset:49152
    ds_read_b64_tr_b16 v[62:63], v15 offset:49664
    s_waitcnt lgkmcnt(6)
    v_mfma_f32_16x16x32_bf16 v[80:83], v[72:75], v[48:51], v[80:83]
    v_mfma_f32_16x16x32_bf16 v[84:87], v[76:79], v[48:51], v[84:87]
    v_mfma_f32_16x16x32_bf16 v[88:91], v[72:75], v[52:55], v[88:91]
    v_mfma_f32_16x16x32_bf16 v[92:95], v[76:79], v[52:55], v[92:95]
    s_barrier
    ds_read_b128 v[40:43], v104 offset:0
    ds_read_b128 v[44:47], v104 offset:2048
    ds_read_b64_tr_b16 v[64:65], v12 offset:0
    ds_read_b64_tr_b16 v[66:67], v12 offset:512
    ds_read_b64_tr_b16 v[68:69], v13 offset:0
    ds_read_b64_tr_b16 v[70:71], v13 offset:512
    s_waitcnt lgkmcnt(6)
    v_mfma_f32_16x16x32_bf16 v[80:83], v[56:59], v[32:35], v[80:83]
    v_mfma_f32_16x16x32_bf16 v[84:87], v[60:63], v[32:35], v[84:87]
    v_mfma_f32_16x16x32_bf16 v[88:91], v[56:59], v[36:39], v[88:91]
    v_mfma_f32_16x16x32_bf16 v[92:95], v[60:63], v[36:39], v[92:95]
    s_barrier
    ds_read_b128 v[48:51], v104 offset:16384
    ds_read_b128 v[52:55], v104 offset:18432
    ds_read_b64_tr_b16 v[72:73], v12 offset:16384
    ds_read_b64_tr_b16 v[74:75], v12 offset:16896
    ds_read_b64_tr_b16 v[76:77], v13 offset:16384
    ds_read_b64_tr_b16 v[78:79], v13 offset:16896
    s_waitcnt lgkmcnt(6)
    v_mfma_f32_16x16x32_bf16 v[80:83], v[64:67], v[40:43], v[80:83]
    v_mfma_f32_16x16x32_bf16 v[84:87], v[68:71], v[40:43], v[84:87]
    v_mfma_f32_16x16x32_bf16 v[88:91], v[64:67], v[44:47], v[88:91]
    v_mfma_f32_16x16x32_bf16 v[92:95], v[68:71], v[44:47], v[92:95]
    s_barrier
    ds_read_b128 v[32:35], v104 offset:32768
    ds_read_b128 v[36:39], v104 offset:34816
    ds_read_b64_tr_b16 v[56:57], v12 offset:32768
    ds_read_b64_tr_b16 v[58:59], v12 offset:33280
    ds_read_b64_tr_b16 v[60:61], v13 offset:32768
    ds_read_b64_tr_b16 v[62:63], v13 offset:33280
    s_waitcnt lgkmcnt(6)
    v_mfma_f32_16x16x32_bf16 v[80:83], v[72:75], v[48:51], v[80:83]
    v_mfma_f32_16x16x32_bf16 v[84:87], v[76:79], v[48:51], v[84:87]
    v_mfma_f32_16x16x32_bf16 v[88:91], v[72:75], v[52:55], v[88:91]
    v_mfma_f32_16x16x32_bf16 v[92:95], v[76:79], v[52:55], v[92:95]
    s_barrier
    ds_read_b128 v[40:43], v104 offset:49152
    ds_read_b128 v[44:47], v104 offset:51200
    ds_read_b64_tr_b16 v[64:65], v12 offset:49152
    ds_read_b64_tr_b16 v[66:67], v12 offset:49664
    ds_read_b64_tr_b16 v[68:69], v13 offset:49152
    ds_read_b64_tr_b16 v[70:71], v13 offset:49664
    s_waitcnt lgkmcnt(6)
    v_mfma_f32_16x16x32_bf16 v[80:83], v[56:59], v[32:35], v[80:83]
    v_mfma_f32_16x16x32_bf16 v[84:87], v[60:63], v[32:35], v[84:87]
    v_mfma_f32_16x16x32_bf16 v[88:91], v[56:59], v[36:39], v[88:91]
    v_mfma_f32_16x16x32_bf16 v[92:95], v[60:63], v[36:39], v[92:95]
    s_barrier
    ds_read_b128 v[48:51], v105 offset:0
    ds_read_b128 v[52:55], v105 offset:2048
    ds_read_b64_tr_b16 v[72:73], v14 offset:0
    ds_read_b64_tr_b16 v[74:75], v14 offset:512
    ds_read_b64_tr_b16 v[76:77], v15 offset:0
    ds_read_b64_tr_b16 v[78:79], v15 offset:512
    s_waitcnt lgkmcnt(6)
    v_mfma_f32_16x16x32_bf16 v[80:83], v[64:67], v[40:43], v[80:83]
    v_mfma_f32_16x16x32_bf16 v[84:87], v[68:71], v[40:43], v[84:87]
    v_mfma_f32_16x16x32_bf16 v[88:91], v[64:67], v[44:47], v[88:91]
    v_mfma_f32_16x16x32_bf16 v[92:95], v[68:71], v[44:47], v[92:95]
    s_barrier
    ds_read_b128 v[32:35], v105 offset:16384
    ds_read_b128 v[36:39], v105 offset:18432
    ds_read_b64_tr_b16 v[56:57], v14 offset:16384
    ds_read_b64_tr_b16 v[58:59], v14 offset:16896
    ds_read_b64_tr_b16 v[60:61], v15 offset:16384
    ds_read_b64_tr_b16 v[62:63], v15 offset:16896
    s_waitcnt lgkmcnt(6)
    v_mfma_f32_16x16x32_bf16 v[80:83], v[72:75], v[48:51], v[80:83]
    v_mfma_f32_16x16x32_bf16 v[84:87], v[76:79], v[48:51], v[84:87]
    v_mfma_f32_16x16x32_bf16 v[88:91], v[72:75], v[52:55], v[88:91]
    v_mfma_f32_16x16x32_bf16 v[92:95], v[76:79], v[52:55], v[92:95]
    s_barrier
    ds_read_b128 v[40:43], v105 offset:32768
    ds_read_b128 v[44:47], v105 offset:34816
    ds_read_b64_tr_b16 v[64:65], v14 offset:32768
    ds_read_b64_tr_b16 v[66:67], v14 offset:33280
    ds_read_b64_tr_b16 v[68:69], v15 offset:32768
    ds_read_b64_tr_b16 v[70:71], v15 offset:33280
    s_waitcnt lgkmcnt(6)
    v_mfma_f32_16x16x32_bf16 v[80:83], v[56:59], v[32:35], v[80:83]
    v_mfma_f32_16x16x32_bf16 v[84:87], v[60:63], v[32:35], v[84:87]
    v_mfma_f32_16x16x32_bf16 v[88:91], v[56:59], v[36:39], v[88:91]
    v_mfma_f32_16x16x32_bf16 v[92:95], v[60:63], v[36:39], v[92:95]
    s_barrier
    ds_read_b128 v[48:51], v105 offset:49152
    ds_read_b128 v[52:55], v105 offset:51200
    ds_read_b64_tr_b16 v[72:73], v14 offset:49152
    ds_read_b64_tr_b16 v[74:75], v14 offset:49664
    ds_read_b64_tr_b16 v[76:77], v15 offset:49152
    ds_read_b64_tr_b16 v[78:79], v15 offset:49664
    s_waitcnt lgkmcnt(6)
    v_mfma_f32_16x16x32_bf16 v[80:83], v[64:67], v[40:43], v[80:83]
    v_mfma_f32_16x16x32_bf16 v[84:87], v[68:71], v[40:43], v[84:87]
    v_mfma_f32_16x16x32_bf16 v[88:91], v[64:67], v[44:47], v[88:91]
    v_mfma_f32_16x16x32_bf16 v[92:95], v[68:71], v[44:47], v[92:95]
    s_barrier
    ds_read_b128 v[32:35], v104 offset:0
    ds_read_b128 v[36:39], v104 offset:2048
    ds_read_b64_tr_b16 v[56:57], v12 offset:0
    ds_read_b64_tr_b16 v[58:59], v12 offset:512
    ds_read_b64_tr_b16 v[60:61], v13 offset:0
    ds_read_b64_tr_b16 v[62:63], v13 offset:512
    s_waitcnt lgkmcnt(6)
    v_mfma_f32_16x16x32_bf16 v[80:83], v[72:75], v[48:51], v[80:83]
    v_mfma_f32_16x16x32_bf16 v[84:87], v[76:79], v[48:51], v[84:87]
    v_mfma_f32_16x16x32_bf16 v[88:91], v[72:75], v[52:55], v[88:91]
    v_mfma_f32_16x16x32_bf16 v[92:95], v[76:79], v[52:55], v[92:95]
    s_barrier
    ds_read_b128 v[40:43], v104 offset:16384
    ds_read_b128 v[44:47], v104 offset:18432
    ds_read_b64_tr_b16 v[64:65], v12 offset:16384
    ds_read_b64_tr_b16 v[66:67], v12 offset:16896
    ds_read_b64_tr_b16 v[68:69], v13 offset:16384
    ds_read_b64_tr_b16 v[70:71], v13 offset:16896
    s_waitcnt lgkmcnt(6)
    v_mfma_f32_16x16x32_bf16 v[80:83], v[56:59], v[32:35], v[80:83]
    v_mfma_f32_16x16x32_bf16 v[84:87], v[60:63], v[32:35], v[84:87]
    v_mfma_f32_16x16x32_bf16 v[88:91], v[56:59], v[36:39], v[88:91]
    v_mfma_f32_16x16x32_bf16 v[92:95], v[60:63], v[36:39], v[92:95]
    s_barrier
    ds_read_b128 v[48:51], v104 offset:32768
    ds_read_b128 v[52:55], v104 offset:34816
    ds_read_b64_tr_b16 v[72:73], v12 offset:32768
    ds_read_b64_tr_b16 v[74:75], v12 offset:33280
    ds_read_b64_tr_b16 v[76:77], v13 offset:32768
    ds_read_b64_tr_b16 v[78:79], v13 offset:33280
    s_waitcnt lgkmcnt(6)
    v_mfma_f32_16x16x32_bf16 v[80:83], v[64:67], v[40:43], v[80:83]
    v_mfma_f32_16x16x32_bf16 v[84:87], v[68:71], v[40:43], v[84:87]
    v_mfma_f32_16x16x32_bf16 v[88:91], v[64:67], v[44:47], v[88:91]
    v_mfma_f32_16x16x32_bf16 v[92:95], v[68:71], v[44:47], v[92:95]
    s_barrier
    ds_read_b128 v[32:35], v104 offset:49152
    ds_read_b128 v[36:39], v104 offset:51200
    ds_read_b64_tr_b16 v[56:57], v12 offset:49152
    ds_read_b64_tr_b16 v[58:59], v12 offset:49664
    ds_read_b64_tr_b16 v[60:61], v13 offset:49152
    ds_read_b64_tr_b16 v[62:63], v13 offset:49664
    s_waitcnt lgkmcnt(6)
    v_mfma_f32_16x16x32_bf16 v[80:83], v[72:75], v[48:51], v[80:83]
    v_mfma_f32_16x16x32_bf16 v[84:87], v[76:79], v[48:51], v[84:87]
    v_mfma_f32_16x16x32_bf16 v[88:91], v[72:75], v[52:55], v[88:91]
    v_mfma_f32_16x16x32_bf16 v[92:95], v[76:79], v[52:55], v[92:95]
    s_waitcnt lgkmcnt(0)
    v_mfma_f32_16x16x32_bf16 v[80:83], v[56:59], v[32:35], v[80:83]
    v_mfma_f32_16x16x32_bf16 v[84:87], v[60:63], v[32:35], v[84:87]
    v_mfma_f32_16x16x32_bf16 v[88:91], v[56:59], v[36:39], v[88:91]
    v_mfma_f32_16x16x32_bf16 v[92:95], v[60:63], v[36:39], v[92:95]
    s_lshl_b32 s3, s9, 5
    s_lshl_b32 s12, s11, 4
    s_add_u32 s12, s3, s12
    v_add_u32 v8, s12, v9
    v_lshlrev_b32 v5, 7, v8
    v_lshl_add_u32 v5, v10, 3, v5
    s_lshl_b32 s3, s10, 6
    s_add_u32 s3, s3, 131072
    v_add_u32 v5, s3, v5
    ds_read_b64 v[96:97], v5
    ds_read_b64 v[98:99], v5 offset:32
    ds_read_b64 v[100:101], v5 offset:8192
    ds_read_b64 v[102:103], v5 offset:8224
    v_lshlrev_b32 v1, 4, v2
    v_add_u32 v1, 147456, v1
    s_lshl_b32 s3, s8, 11
    v_add_u32 v3, s3, v1
    s_xor_b32 s3, s8, 4
    s_lshl_b32 s3, s3, 11
    v_add_u32 v4, s3, v1
    s_cmp_eq_u32 s11, 0
    s_cselect_b64 vcc, -1, 0
    v_cndmask_b32 v112, v80, v88, vcc
    v_cndmask_b32 v80, v88, v80, vcc
    v_cndmask_b32 v113, v81, v89, vcc
    v_cndmask_b32 v81, v89, v81, vcc
    v_cndmask_b32 v114, v82, v90, vcc
    v_cndmask_b32 v82, v90, v82, vcc
    v_cndmask_b32 v115, v83, v91, vcc
    v_cndmask_b32 v83, v91, v83, vcc
    v_cndmask_b32 v116, v84, v92, vcc
    v_cndmask_b32 v84, v92, v84, vcc
    v_cndmask_b32 v117, v85, v93, vcc
    v_cndmask_b32 v85, v93, v85, vcc
    v_cndmask_b32 v118, v86, v94, vcc
    v_cndmask_b32 v86, v94, v86, vcc
    v_cndmask_b32 v119, v87, v95, vcc
    v_cndmask_b32 v87, v95, v87, vcc
    ds_write_b128 v3, v[112:115]
    ds_write_b128 v3, v[116:119] offset:1024
    s_waitcnt lgkmcnt(0)
    s_barrier
    ds_read_b128 v[112:115], v4
    ds_read_b128 v[116:119], v4 offset:1024
    s_waitcnt lgkmcnt(0)
    v_add_f32 v80, v80, v112
    v_add_f32 v81, v81, v113
    v_add_f32 v82, v82, v114
    v_add_f32 v83, v83, v115
    v_add_f32 v84, v84, v116
    v_add_f32 v85, v85, v117
    v_add_f32 v86, v86, v118
    v_add_f32 v87, v87, v119
    s_lshl_b32 s3, s9, 5
    s_lshl_b32 s12, s11, 4
    s_add_u32 s3, s3, s12
    v_add_u32 v5, s3, v9
    v_mul_u32_u24 v5, 144, v5
    v_lshl_add_u32 v5, v10, 3, v5
    s_lshl_b32 s3, s10, 6
    s_add_u32 s3, s3, 36864
    v_add_u32 v5, s3, v5
    v_lshrrev_b32 v1, 3, v2
    s_lshl_b32 s3, s8, 3
    v_add_u32 v1, s3, v1
    v_and_b32 v7, 7, v2
    v_mul_u32_u24 v6, 144, v1
    v_lshl_add_u32 v6, v7, 4, v6
    v_add_u32 v6, 36864, v6
    s_lshl_b32 s3, s4, 6
    v_add_u32 v1, s3, v1
    v_lshlrev_b32 v1, 10, v1
    v_lshl_add_u32 v7, v7, 4, v1
    s_lshl_b32 s3, s5, 7
    v_add_u32 v7, s3, v7
    v_cvt_pk_bf16_f32 v24, v80, v81
    v_cvt_pk_bf16_f32 v25, v82, v83
    v_lshlrev_b32 v80, 16, v24
    v_and_b32 v81, s23, v24
    v_lshlrev_b32 v82, 16, v25
    v_and_b32 v83, s23, v25
    v_lshlrev_b32 v24, 16, v96
    v_and_b32 v25, s23, v96
    v_lshlrev_b32 v26, 16, v97
    v_and_b32 v27, s23, v97
    v_pk_add_f32 v[80:81], v[80:81], v[24:25]
    v_pk_add_f32 v[82:83], v[82:83], v[26:27]
    v_cvt_pk_bf16_f32 v24, v80, v81
    v_cvt_pk_bf16_f32 v25, v82, v83
    v_lshlrev_b32 v80, 16, v24
    v_and_b32 v81, s23, v24
    v_lshlrev_b32 v82, 16, v25
    v_and_b32 v83, s23, v25
    v_lshlrev_b32 v24, 16, v100
    v_and_b32 v25, s23, v100
    v_lshlrev_b32 v26, 16, v101
    v_and_b32 v27, s23, v101
    v_pk_add_f32 v[80:81], v[80:81], v[24:25]
    v_pk_add_f32 v[82:83], v[82:83], v[26:27]
    v_cvt_pk_bf16_f32 v56, v80, v81
    v_cvt_pk_bf16_f32 v57, v82, v83
    ds_write_b64 v5, v[56:57] offset:0
    v_cvt_pk_bf16_f32 v24, v84, v85
    v_cvt_pk_bf16_f32 v25, v86, v87
    v_lshlrev_b32 v84, 16, v24
    v_and_b32 v85, s23, v24
    v_lshlrev_b32 v86, 16, v25
    v_and_b32 v87, s23, v25
    v_lshlrev_b32 v24, 16, v98
    v_and_b32 v25, s23, v98
    v_lshlrev_b32 v26, 16, v99
    v_and_b32 v27, s23, v99
    v_pk_add_f32 v[84:85], v[84:85], v[24:25]
    v_pk_add_f32 v[86:87], v[86:87], v[26:27]
    v_cvt_pk_bf16_f32 v24, v84, v85
    v_cvt_pk_bf16_f32 v25, v86, v87
    v_lshlrev_b32 v84, 16, v24
    v_and_b32 v85, s23, v24
    v_lshlrev_b32 v86, 16, v25
    v_and_b32 v87, s23, v25
    v_lshlrev_b32 v24, 16, v102
    v_and_b32 v25, s23, v102
    v_lshlrev_b32 v26, 16, v103
    v_and_b32 v27, s23, v103
    v_pk_add_f32 v[84:85], v[84:85], v[24:25]
    v_pk_add_f32 v[86:87], v[86:87], v[26:27]
    v_cvt_pk_bf16_f32 v58, v84, v85
    v_cvt_pk_bf16_f32 v59, v86, v87
    ds_write_b64 v5, v[58:59] offset:32
    s_waitcnt lgkmcnt(0)
    s_barrier
    ds_read_b128 v[32:35], v6
    s_waitcnt lgkmcnt(0)
    global_store_dwordx4 v7, v[32:35], s[72:73] sc1
K6_CODE_END:
K6_END:
    s_endpgm
.section .rodata,"a"
.p2align 6
.amdhsa_kernel k2_kernel
  .amdhsa_next_free_vgpr 208
  .amdhsa_next_free_sgpr 64
  .amdhsa_accum_offset 208
  .amdhsa_group_segment_fixed_size 0
  .amdhsa_kernarg_size 136
  .amdhsa_user_sgpr_count 2
  .amdhsa_user_sgpr_kernarg_segment_ptr 1
  .amdhsa_system_sgpr_workgroup_id_x 1
.end_amdhsa_kernel
.p2align 6
.amdhsa_kernel k3_kernel
  .amdhsa_next_free_vgpr 128
  .amdhsa_next_free_sgpr 80
  .amdhsa_accum_offset 128
  .amdhsa_group_segment_fixed_size 0
  .amdhsa_kernarg_size 136
  .amdhsa_user_sgpr_count 2
  .amdhsa_user_sgpr_kernarg_segment_ptr 1
  .amdhsa_system_sgpr_workgroup_id_x 1
.end_amdhsa_kernel
.p2align 6
.amdhsa_kernel k4_kernel
  .amdhsa_next_free_vgpr 128
  .amdhsa_next_free_sgpr 80
  .amdhsa_accum_offset 128
  .amdhsa_group_segment_fixed_size 0
  .amdhsa_kernarg_size 136
  .amdhsa_user_sgpr_count 2
  .amdhsa_user_sgpr_kernarg_segment_ptr 1
  .amdhsa_system_sgpr_workgroup_id_x 1
.end_amdhsa_kernel
.p2align 6
.amdhsa_kernel k5_kernel
  .amdhsa_next_free_vgpr 160
  .amdhsa_next_free_sgpr 80
  .amdhsa_accum_offset 160
  .amdhsa_group_segment_fixed_size 0
  .amdhsa_kernarg_size 136
  .amdhsa_user_sgpr_count 2
  .amdhsa_user_sgpr_kernarg_segment_ptr 1
  .amdhsa_system_sgpr_workgroup_id_x 1
.end_amdhsa_kernel
.p2align 6
.amdhsa_kernel k6_kernel
  .amdhsa_next_free_vgpr 128
  .amdhsa_next_free_sgpr 80
  .amdhsa_accum_offset 128
  .amdhsa_group_segment_fixed_size 0
  .amdhsa_kernarg_size 136
  .amdhsa_user_sgpr_count 2
  .amdhsa_user_sgpr_kernarg_segment_ptr 1
  .amdhsa_system_sgpr_workgroup_id_x 1
.end_amdhsa_kernel
```
